```python
import torch

def _softmax(x, axis=-1):
    return torch.softmax(x, dim=axis)
def _gelu(x):
    return torch.nn.functional.gelu(x, approximate="tanh")
def _silu(x):
    return torch.nn.functional.silu(x)
def _sigmoid(x):
    return torch.sigmoid(x)
def _layernorm(x, axis=-1, eps=1e-5):
    m = x.mean(dim=axis, keepdim=True)
    v = x.var(dim=axis, keepdim=True, unbiased=False)
    return (x - m) / torch.sqrt(v + eps)
def _scatter_add(tgt, idx, src, axis=0):
    return tgt.clone().index_add_(axis, idx, src)
def _segment_sum(src, seg, n):
    out = torch.zeros((n,) + src.shape[1:], dtype=src.dtype)
    return out.index_add_(0, seg, src)
def _pad(x, pw):
    flat = tuple(v for pair in reversed(pw) for v in pair)
    return torch.nn.functional.pad(x, flat)

kernel_name = 'concat_heads__gqa_block_cached__gqa_block_cached__near_ridge'

def setup_inputs():

    _w = (lambda a: (lambda t: t.to(torch.bfloat16) if t.is_floating_point() else t)(torch.as_tensor(a)))
    def _A_setup():
        B, Sq, D = 32, 32, 512
        Hq, Hkv, Sk, Dh = 32, 8, 512, 128
        assert Hq % Hkv == 0, (Hq, Hkv)
        return {
            "x": _w((lambda *s: torch.randn(*s, dtype=torch.bfloat16) * 0.8)(B, Sq, D)),
            "k_cache": _w((lambda *s: torch.randn(*s, dtype=torch.bfloat16) * 0.8)(B, Hkv, Sk, Dh)),
            "v_cache": _w((lambda *s: torch.randn(*s, dtype=torch.bfloat16) * 0.05)(B, Hkv, Sk, Dh)),
            "wq": _w((lambda *s: torch.randn(*s, dtype=torch.bfloat16) * 0.8)(D, Hq * Dh) * (D ** -0.5)),
            "wo": _w((lambda *s: torch.randn(*s, dtype=torch.bfloat16) * 0.05)(Hq * Dh, D) * ((Hq * Dh) ** -0.5)),
        }
    _A_in = _A_setup()

    def _B_setup():
        B, Sq, D = 32, 32, 512
        Hq, Hkv, Sk, Dh = 32, 8, 512, 128
        assert Hq % Hkv == 0, (Hq, Hkv)
        return {
            "x": _w((lambda *s: torch.randn(*s, dtype=torch.bfloat16) * 0.8)(B, Sq, D)),
            "k_cache": _w((lambda *s: torch.randn(*s, dtype=torch.bfloat16) * 0.8)(B, Hkv, Sk, Dh)),
            "v_cache": _w((lambda *s: torch.randn(*s, dtype=torch.bfloat16) * 0.05)(B, Hkv, Sk, Dh)),
            "wq": _w((lambda *s: torch.randn(*s, dtype=torch.bfloat16) * 0.8)(D, Hq * Dh) * (D ** -0.5)),
            "wo": _w((lambda *s: torch.randn(*s, dtype=torch.bfloat16) * 0.05)(Hq * Dh, D) * ((Hq * Dh) ** -0.5)),
        }
    _B_in = _B_setup()

    return {
        "A_x": _A_in["x"],
        "A_k_cache": _A_in["k_cache"],
        "A_v_cache": _A_in["v_cache"],
        "A_wq": _A_in["wq"],
        "A_wo": _A_in["wo"],
        "B_x": _B_in["x"],
        "B_k_cache": _B_in["k_cache"],
        "B_v_cache": _B_in["v_cache"],
        "B_wq": _B_in["wq"],
        "B_wo": _B_in["wo"],
    }

def reference(A_x, A_k_cache, A_v_cache, A_wq, A_wo, B_x, B_k_cache, B_v_cache, B_wq, B_wo):
    def _A_ref(x, k_cache, v_cache, wq, wo):
        B, Sq, D = x.shape
        Hq, Dh = 32, 128
        Hkv = k_cache.shape[1]
        rep = Hq // Hkv
        q = (lambda x, *d: x.permute(*d))((x @ wq).reshape(B, Sq, Hq, Dh), 0, 2, 1, 3)
        k = (lambda x, n, axis: torch.repeat_interleave(x, n, dim=axis))(k_cache, rep, axis=1)
        v = (lambda x, n, axis: torch.repeat_interleave(x, n, dim=axis))(v_cache, rep, axis=1)
        scores = torch.einsum("bhqd,bhkd->bhqk", q, k) * (Dh ** -0.5)
        p = _softmax(scores, axis=-1)
        o = torch.einsum("bhqk,bhkd->bhqd", p, v)
        return (lambda x, *d: x.permute(*d))(o, 0, 2, 1, 3).reshape(B, Sq, Hq * Dh) @ wo

    def _B_ref(x, k_cache, v_cache, wq, wo):
        B, Sq, D = x.shape
        Hq, Dh = 32, 128
        Hkv = k_cache.shape[1]
        rep = Hq // Hkv
        q = (lambda x, *d: x.permute(*d))((x @ wq).reshape(B, Sq, Hq, Dh), 0, 2, 1, 3)
        k = (lambda x, n, axis: torch.repeat_interleave(x, n, dim=axis))(k_cache, rep, axis=1)
        v = (lambda x, n, axis: torch.repeat_interleave(x, n, dim=axis))(v_cache, rep, axis=1)
        scores = torch.einsum("bhqd,bhkd->bhqk", q, k) * (Dh ** -0.5)
        p = _softmax(scores, axis=-1)
        o = torch.einsum("bhqk,bhkd->bhqd", p, v)
        return (lambda x, *d: x.permute(*d))(o, 0, 2, 1, 3).reshape(B, Sq, Hq * Dh) @ wo

    a = _A_ref(A_x, A_k_cache, A_v_cache, A_wq, A_wo)
    b = _B_ref(B_x, B_k_cache, B_v_cache, B_wq, B_wo)
    return torch.concatenate([a, b], axis=-1)
```

```asm
; @launch grid=(256,1,1) block=(512,1,1) lds=163840
.amdgcn_target "amdgcn-amd-amdhsa--gfx950"
.text
.globl concat_heads__gqa_block_cached__gqa_block_cached__near_ridge_kernel
.p2align 8
.type concat_heads__gqa_block_cached__gqa_block_cached__near_ridge_kernel,@function
concat_heads__gqa_block_cached__gqa_block_cached__near_ridge_kernel:
    s_cmp_ge_u32 s2, 256
    s_cbranch_scc1 L_exit
    s_load_dwordx16 s[16:31], s[0:1], 0
    s_load_dwordx8 s[32:39], s[0:1], 64
    s_load_dwordx2 s[40:41], s[0:1], 96

    v_lshrrev_b32 v2, 6, v0
    v_and_b32 v1, 63, v0
    s_and_b32 s4, s2, 3
    v_readfirstlane_b32 s3, v2
    s_bfe_u32 s10, s2, 0x10003
    s_lshl_b32 s4, s4, 1
    s_or_b32 s4, s4, s10
    s_bfe_u32 s6, s2, 0x10002
    s_lshr_b32 s7, s2, 4
    v_lshlrev_b32 v49, 4, v1
    s_and_b32 s9, s7, 3
    s_lshl_b32 s9, s9, 1
    s_lshr_b32 s74, s7, 2
    s_lshl_b32 s74, s74, 3
    s_mov_b32 s54, 0x400000
    s_mov_b32 s55, 0x00020000
    s_mov_b32 s66, 0x100000
    s_mov_b32 s67, 0x00020000
    v_lshrrev_b32 v40, 4, v1
    v_and_b32 v41, 15, v1
    v_xor_b32 v42, v41, v40
    v_lshlrev_b32 v42, 4, v42
    v_lshl_add_u32 v58, v40, 10, v42
    v_lshl_add_u32 v54, v40, 8, v42
    v_mov_b32 v50, v49

    v_xor_b32 v51, 32, v49
    v_xor_b32 v59, 64, v58
    v_add_u32 v51, 7168, v51
    v_add_u32 v59, 3072, v59
    v_xor_b32 v52, 64, v49
    v_xor_b32 v60, 128, v58
    v_add_u32 v52, 14336, v52
    v_add_u32 v60, 6144, v60
    v_xor_b32 v53, 96, v49
    v_xor_b32 v61, 192, v58
    v_add_u32 v53, 21504, v53
    v_add_u32 v61, 9216, v61
    s_bfe_u32 s14, s3, 0x10001
    s_and_b32 s15, s3, 1
    s_mul_i32 s79, s14, 49152
    s_lshl_b32 s99, s14, 15
    s_lshl_b32 s97, s7, 1
    s_add_u32 s97, s97, s14
    s_lshl_b32 s96, s97, 3
    s_add_u32 s96, s96, s4
    s_lshl_b32 s96, s96, 17
    s_lshl_b32 s97, s97, 1
    s_add_u32 s97, s97, s15
    s_lshl_b32 s97, s97, 14
    s_lshl_b32 s15, s15, 12
    s_add_u32 s79, s79, s15
    s_add_u32 s99, s99, s15
    s_add_u32 s99, s99, 98304
    s_add_u32 s96, s96, s15
    s_and_b32 s14, s3, 3
    s_lshl_b32 s14, s14, 15
    s_lshl_b32 s78, s4, 10
    s_add_u32 s78, s78, s14
    s_lshl_b32 s98, s9, 17
    s_lshl_b32 s100, s74, 17
    s_add_u32 s101, s100, s78
    s_cmp_lt_u32 s3, 4
    s_cbranch_scc1 L_setup

    s_cmp_lg_u32 s10, 0
    s_cbranch_scc1 L_initL
    s_add_u32 s75, s98, s101
    s_add_u32 m0, s79, 32768
    s_cmp_eq_u32 s6, 0
    s_waitcnt lgkmcnt(0)
    s_cselect_b32 s52, s22, s32
    s_cselect_b32 s53, s23, s33
    s_cselect_b32 s64, s16, s26
    s_cselect_b32 s65, s17, s27

    buffer_load_dwordx4 v50, s[52:55], s75 offen offset:0 nt lds
    s_add_u32 s14, s74, 0
    s_and_b32 s14, s14, 24
    s_lshl_b32 s14, s14, 5
    s_add_u32 s72, s14, s97
    buffer_load_dwordx4 v51, s[52:55], s75 offen offset:1024 nt lds
    buffer_load_dwordx4 v52, s[52:55], s75 offen offset:2048 nt lds
    buffer_load_dwordx4 v53, s[52:55], s75 offen offset:3072 nt lds
    s_add_u32 m0, s99, 0
    s_nop 0
    buffer_load_dwordx4 v58, s[64:67], s72 offen offset:0 lds
    s_add_u32 s98, s98, 131072
    s_and_b32 s98, s98, 917504
    s_add_u32 s75, s98, s101
    buffer_load_dwordx4 v59, s[64:67], s72 offen offset:1024 lds
    buffer_load_dwordx4 v60, s[64:67], s72 offen offset:2048 lds
    buffer_load_dwordx4 v61, s[64:67], s72 offen offset:3072 lds
    s_add_u32 m0, s79, 40960
    s_nop 0
    buffer_load_dwordx4 v50, s[52:55], s75 offen offset:0 nt lds
    buffer_load_dwordx4 v51, s[52:55], s75 offen offset:1024 nt lds
    buffer_load_dwordx4 v52, s[52:55], s75 offen offset:2048 nt lds
    buffer_load_dwordx4 v53, s[52:55], s75 offen offset:3072 nt lds
    s_branch L_setup
L_initL:
    s_mov_b32 s10, 2
    s_add_u32 s14, s74, 8
    s_and_b32 s14, s14, 24
    s_lshl_b32 s14, s14, 5
    s_add_u32 s75, s14, s97
    s_add_u32 m0, s99, 8192
    s_cmp_eq_u32 s6, 0
    s_waitcnt lgkmcnt(0)
    s_cselect_b32 s52, s22, s32
    s_cselect_b32 s53, s23, s33
    s_cselect_b32 s64, s16, s26
    s_cselect_b32 s65, s17, s27

    buffer_load_dwordx4 v58, s[64:67], s75 offen offset:0 lds
    s_add_u32 s14, s74, 16
    s_and_b32 s14, s14, 24
    s_lshl_b32 s14, s14, 5
    s_add_u32 s72, s14, s97
    buffer_load_dwordx4 v59, s[64:67], s75 offen offset:1024 lds
    buffer_load_dwordx4 v60, s[64:67], s75 offen offset:2048 lds
    buffer_load_dwordx4 v61, s[64:67], s75 offen offset:3072 lds
    s_add_u32 m0, s99, 16384
    s_nop 0
    buffer_load_dwordx4 v58, s[64:67], s72 offen offset:0 lds
    s_add_u32 s14, s74, 24
    s_and_b32 s14, s14, 24
    s_lshl_b32 s14, s14, 5
    s_add_u32 s75, s14, s97
    buffer_load_dwordx4 v59, s[64:67], s72 offen offset:1024 lds
    buffer_load_dwordx4 v60, s[64:67], s72 offen offset:2048 lds
    buffer_load_dwordx4 v61, s[64:67], s72 offen offset:3072 lds
    s_add_u32 m0, s99, 24576
    s_nop 0
    buffer_load_dwordx4 v58, s[64:67], s75 offen offset:0 lds
    buffer_load_dwordx4 v59, s[64:67], s75 offen offset:1024 lds
    buffer_load_dwordx4 v60, s[64:67], s75 offen offset:2048 lds
    buffer_load_dwordx4 v61, s[64:67], s75 offen offset:3072 lds
L_setup:
    s_mov_b32 s46, 0x2000000
    s_mov_b32 s47, 0x00020000
    s_mov_b32 s50, 0x2000000
    s_mov_b32 s51, 0x00020000
    s_lshl_b32 s14, s6, 3
    s_lshl_b32 s2, s7, 4
    s_or_b32 s2, s2, s14
    s_or_b32 s2, s2, s4
    v_xor_b32 v55, 64, v54
    v_xor_b32 v56, 0x80, v54
    v_xor_b32 v57, 0xc0, v54
    v_add_u32 v62, s79, v49
    v_add_u32 v63, s99, v49
    s_mov_b32 s58, 0x400000
    s_mov_b32 s59, 0x00020000
    s_mov_b32 s62, 0x10000000
    s_mov_b32 s63, 0x00020000
    s_mov_b32 s76, 0x3e0293ee
    s_mov_b32 s77, s76
    s_mov_b32 s71, 0x44800000
    s_and_b32 s42, s3, 3
    s_lshr_b32 s43, s3, 2

    v_lshrrev_b32 v42, 5, v1
    v_and_b32 v43, 31, v1
    v_bfe_u32 v44, v1, 2, 2
    v_and_b32 v45, 1, v40
    v_lshlrev_b32 v45, 4, v45
    v_bfe_u32 v46, v1, 1, 1
    v_lshl_add_u32 v45, v46, 3, v45
    v_and_b32 v46, 1, v1

    v_lshl_add_u32 v47, v46, 7, v45
    v_lshl_add_u32 v47, v44, 5, v47
    v_lshl_add_u32 v47, v44, 10, v47
    s_lshl_b32 s14, s42, 8
    v_add_u32 v47, s14, v47
    s_mov_b32 s14, 49152
    v_mad_u32_u24 v2, v42, s14, v47
    v_xor_b32 v3, 32, v2
    v_xor_b32 v4, 64, v2
    v_xor_b32 v5, 0x60, v2

    v_xor_b32 v47, v42, v41
    v_lshlrev_b32 v47, 4, v47
    v_lshl_add_u32 v47, v43, 8, v47
    v_add_u32 v10, 98304, v47

    v_lshlrev_b32 v47, 3, v42
    v_xor_b32 v47, v47, v41
    v_lshlrev_b32 v47, 4, v47
    v_lshl_add_u32 v47, v43, 8, v47
    s_mul_i32 s69, s43, 49152
    v_add_u32 v12, s69, v47

    v_xor_b32 v13, 16, v12
    v_xor_b32 v14, 32, v12
    v_xor_b32 v15, 48, v12
    v_xor_b32 v16, 64, v12
    v_xor_b32 v17, 80, v12
    v_xor_b32 v18, 96, v12
    v_xor_b32 v19, 112, v12
    v_lshl_add_u32 v47, v46, 5, v45
    v_lshl_add_u32 v47, v44, 6, v47
    v_lshl_add_u32 v47, v44, 8, v47
    v_lshl_add_u32 v47, v42, 10, v47
    s_lshl_b32 s70, s43, 15
    s_add_u32 s70, s70, 98304
    v_add_u32 v20, s70, v47
    v_xor_b32 v21, 64, v20
    v_xor_b32 v22, 0x80, v20
    v_xor_b32 v23, 0xc0, v20

    v_xor_b32 v47, v41, v40
    v_lshlrev_b32 v47, 4, v47
    v_lshl_add_u32 v47, v40, 8, v47
    s_and_b32 s14, s42, 1
    s_lshl_b32 s15, s14, 7
    v_xor_b32 v24, s15, v47
    v_xor_b32 v25, 64, v24
    v_lshlrev_b32 v47, 2, v40
    v_xor_b32 v47, v41, v47
    v_lshlrev_b32 v47, 4, v47
    v_lshl_add_u32 v26, v40, 8, v47
    s_lshl_b32 s15, s14, 6
    v_xor_b32 v27, s15, v49
    v_xor_b32 v28, 32, v27

    s_lshl_b32 s14, s42, 11
    s_add_u32 s69, s69, s14
    s_add_u32 s70, s70, s14
    s_lshl_b32 s68, s7, 1
    s_add_u32 s68, s68, s43
    s_lshl_b32 s68, s68, 3
    s_add_u32 s68, s68, s4
    s_lshl_b32 s68, s68, 17
    s_add_u32 s68, s68, s14

    s_lshl_b32 s73, s4, 19
    s_lshl_b32 s14, s3, 11
    s_add_u32 s73, s73, s14
    s_and_b32 s14, s42, 1
    s_mul_i32 s15, s14, 49152
    s_add_u32 s15, s15, 40960
    s_lshl_b32 s14, s14, 15
    s_add_u32 s14, s14, 122880
    s_cmp_lt_u32 s42, 2
    s_cselect_b32 s14, s15, s14
    v_add_u32 v48, s14, v49
    s_cmp_eq_u32 s6, 0
    s_waitcnt lgkmcnt(0)
    s_cselect_b32 s44, s18, s28
    s_cselect_b32 s45, s19, s29
    s_cselect_b32 s48, s20, s30
    s_cselect_b32 s49, s21, s31
    s_cselect_b32 s56, s24, s34
    s_cselect_b32 s57, s25, s35
    s_mov_b32 s60, s40
    s_mov_b32 s61, s41
    s_cmp_lt_u32 s3, 4
    s_cbranch_scc1 L_cons
    s_cmp_lg_u32 s10, 0
    s_cbranch_scc1 L_ldL

    s_add_u32 s98, s98, 131072
    s_and_b32 s98, s98, 917504
    s_add_u32 s72, s98, s101
    s_add_u32 m0, s79, 0
    s_nop 0
    buffer_load_dwordx4 v50, s[52:55], s72 offen offset:0 lds
    s_add_u32 s98, s98, 131072
    s_and_b32 s98, s98, 917504
    s_add_u32 s75, s98, s101
    buffer_load_dwordx4 v51, s[52:55], s72 offen offset:1024 lds
    buffer_load_dwordx4 v52, s[52:55], s72 offen offset:2048 lds
    buffer_load_dwordx4 v53, s[52:55], s72 offen offset:3072 lds
    s_add_u32 m0, s79, 8192
    s_nop 0
    buffer_load_dwordx4 v50, s[52:55], s75 offen offset:0 lds
    s_add_u32 s98, s98, 131072
    s_and_b32 s98, s98, 917504
    s_add_u32 s72, s98, s101
    buffer_load_dwordx4 v51, s[52:55], s75 offen offset:1024 lds
    buffer_load_dwordx4 v52, s[52:55], s75 offen offset:2048 lds
    buffer_load_dwordx4 v53, s[52:55], s75 offen offset:3072 lds
    s_add_u32 m0, s79, 16384
    s_waitcnt vmcnt(12)
    s_barrier
    buffer_load_dwordx4 v50, s[52:55], s72 offen offset:0 lds
    s_add_u32 s98, s98, 131072
    s_and_b32 s98, s98, 917504
    s_add_u32 s75, s98, s101
    buffer_load_dwordx4 v51, s[52:55], s72 offen offset:1024 lds
    buffer_load_dwordx4 v52, s[52:55], s72 offen offset:2048 lds
    buffer_load_dwordx4 v53, s[52:55], s72 offen offset:3072 lds
    s_add_u32 m0, s79, 24576
    s_waitcnt vmcnt(12)
    s_barrier
    buffer_load_dwordx4 v50, s[52:55], s75 offen offset:0 lds
    s_add_u32 s98, s98, 131072
    s_and_b32 s98, s98, 917504
    s_add_u32 s72, s98, s101
    buffer_load_dwordx4 v51, s[52:55], s75 offen offset:1024 lds
    buffer_load_dwordx4 v52, s[52:55], s75 offen offset:2048 lds
    buffer_load_dwordx4 v53, s[52:55], s75 offen offset:3072 lds
    s_add_u32 m0, s79, 32768
    s_waitcnt vmcnt(12)
    s_barrier
    buffer_load_dwordx4 v50, s[52:55], s72 offen offset:0 lds
    s_add_u32 s98, s98, 131072
    s_and_b32 s98, s98, 917504
    s_add_u32 s75, s98, s101
    buffer_load_dwordx4 v51, s[52:55], s72 offen offset:1024 lds
    buffer_load_dwordx4 v52, s[52:55], s72 offen offset:2048 lds
    buffer_load_dwordx4 v53, s[52:55], s72 offen offset:3072 lds
    s_add_u32 m0, s79, 40960
    s_waitcnt vmcnt(12)
    s_barrier
    buffer_load_dwordx4 v50, s[52:55], s75 offen offset:0 lds
    s_add_u32 s14, s74, 8
    s_and_b32 s14, s14, 24
    s_lshl_b32 s14, s14, 5
    s_add_u32 s72, s14, s97
    buffer_load_dwordx4 v51, s[52:55], s75 offen offset:1024 lds
    buffer_load_dwordx4 v52, s[52:55], s75 offen offset:2048 lds
    buffer_load_dwordx4 v53, s[52:55], s75 offen offset:3072 lds
    s_add_u32 m0, s99, 8192
    s_waitcnt vmcnt(12)
    s_barrier
    buffer_load_dwordx4 v58, s[64:67], s72 offen offset:0 lds
    s_add_u32 s98, s98, 131072
    s_and_b32 s98, s98, 917504
    s_add_u32 s100, s100, 1048576
    s_and_b32 s100, s100, 3145728
    s_add_u32 s101, s100, s78
    s_add_u32 s75, s98, s101
    buffer_load_dwordx4 v59, s[64:67], s72 offen offset:1024 lds
    buffer_load_dwordx4 v60, s[64:67], s72 offen offset:2048 lds
    buffer_load_dwordx4 v61, s[64:67], s72 offen offset:3072 lds
    s_add_u32 m0, s79, 0
    s_nop 0
    buffer_load_dwordx4 v50, s[52:55], s75 offen offset:0 lds
    s_add_u32 s98, s98, 131072
    s_and_b32 s98, s98, 917504
    s_add_u32 s72, s98, s101
    buffer_load_dwordx4 v51, s[52:55], s75 offen offset:1024 lds
    buffer_load_dwordx4 v52, s[52:55], s75 offen offset:2048 lds
    buffer_load_dwordx4 v53, s[52:55], s75 offen offset:3072 lds
    s_add_u32 m0, s79, 8192
    s_waitcnt vmcnt(16)
    s_barrier
    buffer_load_dwordx4 v50, s[52:55], s72 offen offset:0 lds
    s_add_u32 s98, s98, 131072
    s_and_b32 s98, s98, 917504
    s_add_u32 s75, s98, s101
    buffer_load_dwordx4 v51, s[52:55], s72 offen offset:1024 lds
    buffer_load_dwordx4 v52, s[52:55], s72 offen offset:2048 lds
    buffer_load_dwordx4 v53, s[52:55], s72 offen offset:3072 lds
    s_add_u32 m0, s79, 16384
    s_waitcnt vmcnt(16)
    s_barrier
    buffer_load_dwordx4 v50, s[52:55], s75 offen offset:0 lds
    s_add_u32 s98, s98, 131072
    s_and_b32 s98, s98, 917504
    s_add_u32 s72, s98, s101
    buffer_load_dwordx4 v51, s[52:55], s75 offen offset:1024 lds
    buffer_load_dwordx4 v52, s[52:55], s75 offen offset:2048 lds
    buffer_load_dwordx4 v53, s[52:55], s75 offen offset:3072 lds
    s_add_u32 m0, s79, 24576
    s_waitcnt vmcnt(16)
    s_barrier
    buffer_load_dwordx4 v50, s[52:55], s72 offen offset:0 lds
    s_add_u32 s98, s98, 131072
    s_and_b32 s98, s98, 917504
    s_add_u32 s75, s98, s101
    buffer_load_dwordx4 v51, s[52:55], s72 offen offset:1024 lds
    buffer_load_dwordx4 v52, s[52:55], s72 offen offset:2048 lds
    buffer_load_dwordx4 v53, s[52:55], s72 offen offset:3072 lds
    s_add_u32 m0, s79, 32768
    s_waitcnt vmcnt(12)
    s_barrier
    buffer_load_dwordx4 v50, s[52:55], s75 offen offset:0 lds
    s_add_u32 s98, s98, 131072
    s_and_b32 s98, s98, 917504
    s_add_u32 s72, s98, s101
    buffer_load_dwordx4 v51, s[52:55], s75 offen offset:1024 lds
    buffer_load_dwordx4 v52, s[52:55], s75 offen offset:2048 lds
    buffer_load_dwordx4 v53, s[52:55], s75 offen offset:3072 lds
    s_add_u32 m0, s79, 40960
    s_waitcnt vmcnt(12)
    s_barrier
    buffer_load_dwordx4 v50, s[52:55], s72 offen offset:0 lds
    s_add_u32 s98, s98, 131072
    s_and_b32 s98, s98, 917504
    s_add_u32 s75, s98, s101
    buffer_load_dwordx4 v51, s[52:55], s72 offen offset:1024 lds
    buffer_load_dwordx4 v52, s[52:55], s72 offen offset:2048 lds
    buffer_load_dwordx4 v53, s[52:55], s72 offen offset:3072 lds
    s_add_u32 m0, s79, 0
    s_waitcnt vmcnt(12)
    s_barrier
    buffer_load_dwordx4 v50, s[52:55], s75 offen offset:0 lds
    s_add_u32 s98, s98, 131072
    s_and_b32 s98, s98, 917504
    s_add_u32 s72, s98, s101
    buffer_load_dwordx4 v51, s[52:55], s75 offen offset:1024 lds
    buffer_load_dwordx4 v52, s[52:55], s75 offen offset:2048 lds
    buffer_load_dwordx4 v53, s[52:55], s75 offen offset:3072 lds
    s_add_u32 m0, s79, 8192
    s_waitcnt vmcnt(12)
    s_barrier
    buffer_load_dwordx4 v50, s[52:55], s72 offen offset:0 lds
    s_add_u32 s14, s74, 16
    s_and_b32 s14, s14, 24
    s_lshl_b32 s14, s14, 5
    s_add_u32 s75, s14, s97
    buffer_load_dwordx4 v51, s[52:55], s72 offen offset:1024 lds
    buffer_load_dwordx4 v52, s[52:55], s72 offen offset:2048 lds
    buffer_load_dwordx4 v53, s[52:55], s72 offen offset:3072 lds
    s_add_u32 m0, s99, 16384
    s_waitcnt vmcnt(12)
    s_barrier
    buffer_load_dwordx4 v58, s[64:67], s75 offen offset:0 lds
    s_add_u32 s98, s98, 131072
    s_and_b32 s98, s98, 917504
    s_add_u32 s100, s100, 1048576
    s_and_b32 s100, s100, 3145728
    s_add_u32 s101, s100, s78
    s_add_u32 s72, s98, s101
    buffer_load_dwordx4 v59, s[64:67], s75 offen offset:1024 lds
    buffer_load_dwordx4 v60, s[64:67], s75 offen offset:2048 lds
    buffer_load_dwordx4 v61, s[64:67], s75 offen offset:3072 lds
    s_add_u32 m0, s79, 16384
    s_nop 0
    buffer_load_dwordx4 v50, s[52:55], s72 offen offset:0 lds
    s_add_u32 s98, s98, 131072
    s_and_b32 s98, s98, 917504
    s_add_u32 s75, s98, s101
    buffer_load_dwordx4 v51, s[52:55], s72 offen offset:1024 lds
    buffer_load_dwordx4 v52, s[52:55], s72 offen offset:2048 lds
    buffer_load_dwordx4 v53, s[52:55], s72 offen offset:3072 lds
    s_add_u32 m0, s79, 24576
    s_waitcnt vmcnt(16)
    s_barrier
    buffer_load_dwordx4 v50, s[52:55], s75 offen offset:0 lds
    s_add_u32 s98, s98, 131072
    s_and_b32 s98, s98, 917504
    s_add_u32 s72, s98, s101
    buffer_load_dwordx4 v51, s[52:55], s75 offen offset:1024 lds
    buffer_load_dwordx4 v52, s[52:55], s75 offen offset:2048 lds
    buffer_load_dwordx4 v53, s[52:55], s75 offen offset:3072 lds
    s_add_u32 m0, s79, 32768
    s_waitcnt vmcnt(16)
    s_barrier
    buffer_load_dwordx4 v50, s[52:55], s72 offen offset:0 lds
    s_add_u32 s98, s98, 131072
    s_and_b32 s98, s98, 917504
    s_add_u32 s75, s98, s101
    buffer_load_dwordx4 v51, s[52:55], s72 offen offset:1024 lds
    buffer_load_dwordx4 v52, s[52:55], s72 offen offset:2048 lds
    buffer_load_dwordx4 v53, s[52:55], s72 offen offset:3072 lds
    s_add_u32 m0, s79, 40960
    s_waitcnt vmcnt(16)
    s_barrier
    buffer_load_dwordx4 v50, s[52:55], s75 offen offset:0 lds
    s_add_u32 s98, s98, 131072
    s_and_b32 s98, s98, 917504
    s_add_u32 s72, s98, s101
    buffer_load_dwordx4 v51, s[52:55], s75 offen offset:1024 lds
    buffer_load_dwordx4 v52, s[52:55], s75 offen offset:2048 lds
    buffer_load_dwordx4 v53, s[52:55], s75 offen offset:3072 lds
    s_add_u32 m0, s79, 0
    s_waitcnt vmcnt(12)
    s_barrier
    buffer_load_dwordx4 v50, s[52:55], s72 offen offset:0 lds
    s_add_u32 s98, s98, 131072
    s_and_b32 s98, s98, 917504
    s_add_u32 s75, s98, s101
    buffer_load_dwordx4 v51, s[52:55], s72 offen offset:1024 lds
    buffer_load_dwordx4 v52, s[52:55], s72 offen offset:2048 lds
    buffer_load_dwordx4 v53, s[52:55], s72 offen offset:3072 lds
    s_add_u32 m0, s79, 8192
    s_waitcnt vmcnt(12)
    s_barrier
    buffer_load_dwordx4 v50, s[52:55], s75 offen offset:0 lds
    s_add_u32 s98, s98, 131072
    s_and_b32 s98, s98, 917504
    s_add_u32 s72, s98, s101
    buffer_load_dwordx4 v51, s[52:55], s75 offen offset:1024 lds
    buffer_load_dwordx4 v52, s[52:55], s75 offen offset:2048 lds
    buffer_load_dwordx4 v53, s[52:55], s75 offen offset:3072 lds
    s_add_u32 m0, s79, 16384
    s_waitcnt vmcnt(12)
    s_barrier
    buffer_load_dwordx4 v50, s[52:55], s72 offen offset:0 lds
    s_add_u32 s98, s98, 131072
    s_and_b32 s98, s98, 917504
    s_add_u32 s75, s98, s101
    buffer_load_dwordx4 v51, s[52:55], s72 offen offset:1024 lds
    buffer_load_dwordx4 v52, s[52:55], s72 offen offset:2048 lds
    buffer_load_dwordx4 v53, s[52:55], s72 offen offset:3072 lds
    s_add_u32 m0, s79, 24576
    s_waitcnt vmcnt(12)
    s_barrier
    buffer_load_dwordx4 v50, s[52:55], s75 offen offset:0 lds
    s_add_u32 s14, s74, 24
    s_and_b32 s14, s14, 24
    s_lshl_b32 s14, s14, 5
    s_add_u32 s72, s14, s97
    buffer_load_dwordx4 v51, s[52:55], s75 offen offset:1024 lds
    buffer_load_dwordx4 v52, s[52:55], s75 offen offset:2048 lds
    buffer_load_dwordx4 v53, s[52:55], s75 offen offset:3072 lds
    s_add_u32 m0, s99, 24576
    s_waitcnt vmcnt(12)
    s_barrier
    buffer_load_dwordx4 v58, s[64:67], s72 offen offset:0 lds
    s_add_u32 s98, s98, 131072
    s_and_b32 s98, s98, 917504
    s_add_u32 s100, s100, 1048576
    s_and_b32 s100, s100, 3145728
    s_add_u32 s101, s100, s78
    s_add_u32 s75, s98, s101
    buffer_load_dwordx4 v59, s[64:67], s72 offen offset:1024 lds
    buffer_load_dwordx4 v60, s[64:67], s72 offen offset:2048 lds
    buffer_load_dwordx4 v61, s[64:67], s72 offen offset:3072 lds
    s_add_u32 m0, s79, 32768
    s_nop 0
    buffer_load_dwordx4 v50, s[52:55], s75 offen offset:0 lds
    s_add_u32 s98, s98, 131072
    s_and_b32 s98, s98, 917504
    s_add_u32 s72, s98, s101
    buffer_load_dwordx4 v51, s[52:55], s75 offen offset:1024 lds
    buffer_load_dwordx4 v52, s[52:55], s75 offen offset:2048 lds
    buffer_load_dwordx4 v53, s[52:55], s75 offen offset:3072 lds
    s_add_u32 m0, s79, 40960
    s_waitcnt vmcnt(16)
    s_barrier
    buffer_load_dwordx4 v50, s[52:55], s72 offen offset:0 lds
    s_add_u32 s98, s98, 131072
    s_and_b32 s98, s98, 917504
    s_add_u32 s75, s98, s101
    buffer_load_dwordx4 v51, s[52:55], s72 offen offset:1024 lds
    buffer_load_dwordx4 v52, s[52:55], s72 offen offset:2048 lds
    buffer_load_dwordx4 v53, s[52:55], s72 offen offset:3072 lds
    s_add_u32 m0, s79, 0
    s_waitcnt vmcnt(16)
    s_barrier
    buffer_load_dwordx4 v50, s[52:55], s75 offen offset:0 lds
    s_add_u32 s98, s98, 131072
    s_and_b32 s98, s98, 917504
    s_add_u32 s72, s98, s101
    buffer_load_dwordx4 v51, s[52:55], s75 offen offset:1024 lds
    buffer_load_dwordx4 v52, s[52:55], s75 offen offset:2048 lds
    buffer_load_dwordx4 v53, s[52:55], s75 offen offset:3072 lds
    s_add_u32 m0, s79, 8192
    s_waitcnt vmcnt(16)
    s_barrier
    buffer_load_dwordx4 v50, s[52:55], s72 offen offset:0 lds
    s_add_u32 s98, s98, 131072
    s_and_b32 s98, s98, 917504
    s_add_u32 s75, s98, s101
    buffer_load_dwordx4 v51, s[52:55], s72 offen offset:1024 lds
    buffer_load_dwordx4 v52, s[52:55], s72 offen offset:2048 lds
    buffer_load_dwordx4 v53, s[52:55], s72 offen offset:3072 lds
    s_add_u32 m0, s79, 16384
    s_waitcnt vmcnt(12)
    s_barrier
    buffer_load_dwordx4 v50, s[52:55], s75 offen offset:0 lds
    s_add_u32 s98, s98, 131072
    s_and_b32 s98, s98, 917504
    s_add_u32 s72, s98, s101
    buffer_load_dwordx4 v51, s[52:55], s75 offen offset:1024 lds
    buffer_load_dwordx4 v52, s[52:55], s75 offen offset:2048 lds
    buffer_load_dwordx4 v53, s[52:55], s75 offen offset:3072 lds
    s_add_u32 m0, s79, 24576
    s_waitcnt vmcnt(12)
    s_barrier
    buffer_load_dwordx4 v50, s[52:55], s72 offen offset:0 lds
    s_add_u32 s98, s98, 131072
    s_and_b32 s98, s98, 917504
    s_add_u32 s75, s98, s101
    buffer_load_dwordx4 v51, s[52:55], s72 offen offset:1024 lds
    buffer_load_dwordx4 v52, s[52:55], s72 offen offset:2048 lds
    buffer_load_dwordx4 v53, s[52:55], s72 offen offset:3072 lds
    s_add_u32 m0, s79, 32768
    s_waitcnt vmcnt(12)
    s_barrier
    buffer_load_dwordx4 v50, s[52:55], s75 offen offset:0 lds
    s_add_u32 s98, s98, 131072
    s_and_b32 s98, s98, 917504
    s_add_u32 s72, s98, s101
    buffer_load_dwordx4 v51, s[52:55], s75 offen offset:1024 lds
    buffer_load_dwordx4 v52, s[52:55], s75 offen offset:2048 lds
    buffer_load_dwordx4 v53, s[52:55], s75 offen offset:3072 lds
    s_add_u32 m0, s79, 40960
    s_waitcnt vmcnt(12)
    s_barrier
    buffer_load_dwordx4 v50, s[52:55], s72 offen offset:0 lds
    s_xor_b32 s75, s96, 0
    buffer_load_dwordx4 v51, s[52:55], s72 offen offset:1024 lds
    buffer_load_dwordx4 v52, s[52:55], s72 offen offset:2048 lds
    buffer_load_dwordx4 v53, s[52:55], s72 offen offset:3072 lds
    s_add_u32 m0, s79, 0
    s_waitcnt vmcnt(12)
    s_barrier
    buffer_load_dwordx4 v54, s[44:47], s75 offen offset:0 nt lds
    s_xor_b32 s72, s96, 8192
    buffer_load_dwordx4 v55, s[44:47], s75 offen offset:1024 nt lds
    buffer_load_dwordx4 v56, s[44:47], s75 offen offset:2048 nt lds
    buffer_load_dwordx4 v57, s[44:47], s75 offen offset:3072 nt lds
    s_add_u32 m0, s79, 8192
    s_waitcnt vmcnt(12)
    s_barrier
    buffer_load_dwordx4 v54, s[44:47], s72 offen offset:0 nt lds
    s_xor_b32 s75, s96, 0
    buffer_load_dwordx4 v55, s[44:47], s72 offen offset:1024 nt lds
    buffer_load_dwordx4 v56, s[44:47], s72 offen offset:2048 nt lds
    buffer_load_dwordx4 v57, s[44:47], s72 offen offset:3072 nt lds
    s_add_u32 m0, s99, 0
    s_waitcnt vmcnt(12)
    s_barrier
    buffer_load_dwordx4 v26, s[48:51], s75 offen offset:0 nt lds
    s_xor_b32 s72, s96, 16384
    buffer_load_dwordx4 v26, s[48:51], s75 offen offset:1024 nt lds
    buffer_load_dwordx4 v26, s[48:51], s75 offen offset:2048 nt lds
    buffer_load_dwordx4 v26, s[48:51], s75 offen offset:3072 nt lds
    s_add_u32 m0, s79, 16384
    s_waitcnt vmcnt(12)
    s_barrier
    v_subrev_u32 v51, 7168, v51
    v_subrev_u32 v52, 14336, v52
    v_subrev_u32 v53, 21504, v53
    s_and_b32 s14, s3, 3
    s_lshl_b32 s14, s14, 12
    s_lshl_b32 s78, s4, 19
    s_add_u32 s78, s78, s14

    s_barrier
    buffer_load_dwordx4 v54, s[44:47], s72 offen offset:0 nt lds
    buffer_load_dwordx4 v55, s[44:47], s72 offen offset:1024 nt lds
    buffer_load_dwordx4 v56, s[44:47], s72 offen offset:2048 nt lds
    buffer_load_dwordx4 v57, s[44:47], s72 offen offset:3072 nt lds
    s_waitcnt vmcnt(12)
    s_branch L_getq
L_ldL:
    s_add_u32 s14, s74, 0
    s_and_b32 s14, s14, 24
    s_lshl_b32 s14, s14, 5
    s_add_u32 s72, s14, s97
    s_add_u32 m0, s99, 0
    s_nop 0
    buffer_load_dwordx4 v58, s[64:67], s72 offen offset:0 lds
    s_add_u32 s75, s98, s101
    buffer_load_dwordx4 v59, s[64:67], s72 offen offset:1024 lds
    buffer_load_dwordx4 v60, s[64:67], s72 offen offset:2048 lds
    buffer_load_dwordx4 v61, s[64:67], s72 offen offset:3072 lds
    s_add_u32 m0, s79, 32768
    s_nop 0
    buffer_load_dwordx4 v50, s[52:55], s75 offen offset:0 lds
    s_add_u32 s98, s98, 131072
    s_and_b32 s98, s98, 917504
    s_add_u32 s72, s98, s101
    buffer_load_dwordx4 v51, s[52:55], s75 offen offset:1024 lds
    buffer_load_dwordx4 v52, s[52:55], s75 offen offset:2048 lds
    buffer_load_dwordx4 v53, s[52:55], s75 offen offset:3072 lds
    s_add_u32 m0, s79, 40960
    s_nop 0
    buffer_load_dwordx4 v50, s[52:55], s72 offen offset:0 lds
    s_xor_b32 s75, s96, 0
    buffer_load_dwordx4 v51, s[52:55], s72 offen offset:1024 lds
    buffer_load_dwordx4 v52, s[52:55], s72 offen offset:2048 lds
    buffer_load_dwordx4 v53, s[52:55], s72 offen offset:3072 lds
    buffer_load_dwordx4 v[128:131], v54, s[44:47], s75 offen offset:0 nt
    s_xor_b32 s72, s96, 8192
    buffer_load_dwordx4 v[132:135], v55, s[44:47], s75 offen offset:1024 nt
    buffer_load_dwordx4 v[136:139], v56, s[44:47], s75 offen offset:2048 nt
    buffer_load_dwordx4 v[140:143], v57, s[44:47], s75 offen offset:3072 nt
    buffer_load_dwordx4 v[144:147], v54, s[44:47], s72 offen offset:0 nt
    s_xor_b32 s75, s96, 0
    buffer_load_dwordx4 v[148:151], v55, s[44:47], s72 offen offset:1024 nt
    buffer_load_dwordx4 v[152:155], v56, s[44:47], s72 offen offset:2048 nt
    buffer_load_dwordx4 v[156:159], v57, s[44:47], s72 offen offset:3072 nt
    buffer_load_dwordx4 v[160:163], v26, s[48:51], s75 offen offset:0 nt
    s_xor_b32 s72, s96, 16384
    buffer_load_dwordx4 v[164:167], v26, s[48:51], s75 offen offset:1024 nt
    buffer_load_dwordx4 v[168:171], v26, s[48:51], s75 offen offset:2048 nt
    buffer_load_dwordx4 v[172:175], v26, s[48:51], s75 offen offset:3072 nt
    buffer_load_dwordx4 v[176:179], v54, s[44:47], s72 offen offset:0 nt
    s_xor_b32 s75, s96, 8192
    buffer_load_dwordx4 v[180:183], v55, s[44:47], s72 offen offset:1024 nt
    buffer_load_dwordx4 v[184:187], v56, s[44:47], s72 offen offset:2048 nt
    buffer_load_dwordx4 v[188:191], v57, s[44:47], s72 offen offset:3072 nt
    buffer_load_dwordx4 v[192:195], v26, s[48:51], s75 offen offset:0 nt
    s_xor_b32 s72, s96, 24576
    buffer_load_dwordx4 v[196:199], v26, s[48:51], s75 offen offset:1024 nt
    buffer_load_dwordx4 v[200:203], v26, s[48:51], s75 offen offset:2048 nt
    buffer_load_dwordx4 v[204:207], v26, s[48:51], s75 offen offset:3072 nt
    buffer_load_dwordx4 v[208:211], v54, s[44:47], s72 offen offset:0 nt
    s_xor_b32 s75, s96, 40960
    buffer_load_dwordx4 v[212:215], v55, s[44:47], s72 offen offset:1024 nt
    buffer_load_dwordx4 v[216:219], v56, s[44:47], s72 offen offset:2048 nt
    buffer_load_dwordx4 v[220:223], v57, s[44:47], s72 offen offset:3072 nt
    buffer_load_dwordx4 v[64:67], v54, s[44:47], s75 offen offset:0 nt
    s_xor_b32 s72, s96, 24576
    buffer_load_dwordx4 v[68:71], v55, s[44:47], s75 offen offset:1024 nt
    buffer_load_dwordx4 v[72:75], v56, s[44:47], s75 offen offset:2048 nt
    buffer_load_dwordx4 v[76:79], v57, s[44:47], s75 offen offset:3072 nt
    buffer_load_dwordx4 v[80:83], v26, s[48:51], s72 offen offset:0 nt
    s_xor_b32 s75, s96, 49152
    buffer_load_dwordx4 v[84:87], v26, s[48:51], s72 offen offset:1024 nt
    buffer_load_dwordx4 v[88:91], v26, s[48:51], s72 offen offset:2048 nt
    buffer_load_dwordx4 v[92:95], v26, s[48:51], s72 offen offset:3072 nt
    buffer_load_dwordx4 v[96:99], v54, s[44:47], s75 offen offset:0 nt
    s_xor_b32 s72, s96, 57344
    buffer_load_dwordx4 v[100:103], v55, s[44:47], s75 offen offset:1024 nt
    buffer_load_dwordx4 v[104:107], v56, s[44:47], s75 offen offset:2048 nt
    buffer_load_dwordx4 v[108:111], v57, s[44:47], s75 offen offset:3072 nt
    buffer_load_dwordx4 v[112:115], v54, s[44:47], s72 offen offset:0 nt
    s_add_u32 s98, s98, 131072
    s_and_b32 s98, s98, 917504
    s_add_u32 s75, s98, s101
    buffer_load_dwordx4 v[116:119], v55, s[44:47], s72 offen offset:1024 nt
    buffer_load_dwordx4 v[120:123], v56, s[44:47], s72 offen offset:2048 nt
    buffer_load_dwordx4 v[124:127], v57, s[44:47], s72 offen offset:3072 nt
    s_add_u32 m0, s79, 0
    s_nop 0
    buffer_load_dwordx4 v50, s[52:55], s75 offen offset:0 lds
    s_add_u32 s98, s98, 131072
    s_and_b32 s98, s98, 917504
    s_add_u32 s72, s98, s101
    buffer_load_dwordx4 v51, s[52:55], s75 offen offset:1024 lds
    buffer_load_dwordx4 v52, s[52:55], s75 offen offset:2048 lds
    buffer_load_dwordx4 v53, s[52:55], s75 offen offset:3072 lds
    s_add_u32 m0, s79, 8192
    s_nop 0
    buffer_load_dwordx4 v50, s[52:55], s72 offen offset:0 lds
    s_add_u32 s98, s98, 131072
    s_and_b32 s98, s98, 917504
    s_add_u32 s75, s98, s101
    buffer_load_dwordx4 v51, s[52:55], s72 offen offset:1024 lds
    buffer_load_dwordx4 v52, s[52:55], s72 offen offset:2048 lds
    buffer_load_dwordx4 v53, s[52:55], s72 offen offset:3072 lds
    s_add_u32 m0, s79, 16384
    s_waitcnt vmcnt(52)
    s_barrier
    buffer_load_dwordx4 v50, s[52:55], s75 offen offset:0 lds
    s_add_u32 s98, s98, 131072
    s_and_b32 s98, s98, 917504
    s_add_u32 s72, s98, s101
    buffer_load_dwordx4 v51, s[52:55], s75 offen offset:1024 lds
    buffer_load_dwordx4 v52, s[52:55], s75 offen offset:2048 lds
    buffer_load_dwordx4 v53, s[52:55], s75 offen offset:3072 lds
    s_add_u32 m0, s79, 24576
    s_waitcnt vmcnt(52)
    s_barrier
    buffer_load_dwordx4 v50, s[52:55], s72 offen offset:0 lds
    s_add_u32 s98, s98, 131072
    s_and_b32 s98, s98, 917504
    s_add_u32 s75, s98, s101
    buffer_load_dwordx4 v51, s[52:55], s72 offen offset:1024 lds
    buffer_load_dwordx4 v52, s[52:55], s72 offen offset:2048 lds
    buffer_load_dwordx4 v53, s[52:55], s72 offen offset:3072 lds
    s_add_u32 m0, s79, 32768
    s_waitcnt vmcnt(12)
    s_barrier
    buffer_load_dwordx4 v50, s[52:55], s75 offen offset:0 lds
    s_add_u32 s98, s98, 131072
    s_and_b32 s98, s98, 917504
    s_add_u32 s72, s98, s101
    buffer_load_dwordx4 v51, s[52:55], s75 offen offset:1024 lds
    buffer_load_dwordx4 v52, s[52:55], s75 offen offset:2048 lds
    buffer_load_dwordx4 v53, s[52:55], s75 offen offset:3072 lds
    s_add_u32 m0, s79, 40960
    s_waitcnt vmcnt(12)
    s_barrier
    buffer_load_dwordx4 v50, s[52:55], s72 offen offset:0 lds
    s_add_u32 s98, s98, 131072
    s_and_b32 s98, s98, 917504
    s_add_u32 s100, s100, 1048576
    s_and_b32 s100, s100, 3145728
    s_add_u32 s101, s100, s78
    s_add_u32 s75, s98, s101
    buffer_load_dwordx4 v51, s[52:55], s72 offen offset:1024 lds
    buffer_load_dwordx4 v52, s[52:55], s72 offen offset:2048 lds
    buffer_load_dwordx4 v53, s[52:55], s72 offen offset:3072 lds
    s_add_u32 m0, s79, 0
    s_waitcnt vmcnt(12)
    s_barrier
    buffer_load_dwordx4 v50, s[52:55], s75 offen offset:0 lds
    s_add_u32 s98, s98, 131072
    s_and_b32 s98, s98, 917504
    s_add_u32 s72, s98, s101
    buffer_load_dwordx4 v51, s[52:55], s75 offen offset:1024 lds
    buffer_load_dwordx4 v52, s[52:55], s75 offen offset:2048 lds
    buffer_load_dwordx4 v53, s[52:55], s75 offen offset:3072 lds
    s_add_u32 m0, s79, 8192
    s_waitcnt vmcnt(12)
    s_barrier
    buffer_load_dwordx4 v50, s[52:55], s72 offen offset:0 lds
    s_add_u32 s98, s98, 131072
    s_and_b32 s98, s98, 917504
    s_add_u32 s75, s98, s101
    buffer_load_dwordx4 v51, s[52:55], s72 offen offset:1024 lds
    buffer_load_dwordx4 v52, s[52:55], s72 offen offset:2048 lds
    buffer_load_dwordx4 v53, s[52:55], s72 offen offset:3072 lds
    s_add_u32 m0, s79, 16384
    s_waitcnt vmcnt(12)
    s_barrier
    buffer_load_dwordx4 v50, s[52:55], s75 offen offset:0 lds
    s_add_u32 s98, s98, 131072
    s_and_b32 s98, s98, 917504
    s_add_u32 s72, s98, s101
    buffer_load_dwordx4 v51, s[52:55], s75 offen offset:1024 lds
    buffer_load_dwordx4 v52, s[52:55], s75 offen offset:2048 lds
    buffer_load_dwordx4 v53, s[52:55], s75 offen offset:3072 lds
    s_add_u32 m0, s79, 24576
    s_waitcnt vmcnt(12)
    s_barrier
    buffer_load_dwordx4 v50, s[52:55], s72 offen offset:0 lds
    s_add_u32 s98, s98, 131072
    s_and_b32 s98, s98, 917504
    s_add_u32 s75, s98, s101
    buffer_load_dwordx4 v51, s[52:55], s72 offen offset:1024 lds
    buffer_load_dwordx4 v52, s[52:55], s72 offen offset:2048 lds
    buffer_load_dwordx4 v53, s[52:55], s72 offen offset:3072 lds
    s_add_u32 m0, s79, 32768
    s_waitcnt vmcnt(12)
    s_barrier
    buffer_load_dwordx4 v50, s[52:55], s75 offen offset:0 lds
    s_add_u32 s98, s98, 131072
    s_and_b32 s98, s98, 917504
    s_add_u32 s72, s98, s101
    buffer_load_dwordx4 v51, s[52:55], s75 offen offset:1024 lds
    buffer_load_dwordx4 v52, s[52:55], s75 offen offset:2048 lds
    buffer_load_dwordx4 v53, s[52:55], s75 offen offset:3072 lds
    s_add_u32 m0, s79, 40960
    ds_write_b128 v63, v[160:163] offset:0
    ds_write_b128 v63, v[164:167] offset:1024
    ds_write_b128 v63, v[168:171] offset:2048
    ds_write_b128 v63, v[172:175] offset:3072
    s_waitcnt vmcnt(12)
    s_barrier
    buffer_load_dwordx4 v50, s[52:55], s72 offen offset:0 lds
    s_add_u32 s98, s98, 131072
    s_and_b32 s98, s98, 917504
    s_add_u32 s75, s98, s101
    buffer_load_dwordx4 v51, s[52:55], s72 offen offset:1024 lds
    buffer_load_dwordx4 v52, s[52:55], s72 offen offset:2048 lds
    buffer_load_dwordx4 v53, s[52:55], s72 offen offset:3072 lds
    s_add_u32 m0, s79, 0
    s_waitcnt vmcnt(12)
    s_barrier
    buffer_load_dwordx4 v50, s[52:55], s75 offen offset:0 lds
    s_add_u32 s98, s98, 131072
    s_and_b32 s98, s98, 917504
    s_add_u32 s72, s98, s101
    buffer_load_dwordx4 v51, s[52:55], s75 offen offset:1024 lds
    buffer_load_dwordx4 v52, s[52:55], s75 offen offset:2048 lds
    buffer_load_dwordx4 v53, s[52:55], s75 offen offset:3072 lds
    s_add_u32 m0, s79, 8192
    s_waitcnt vmcnt(12)
    s_barrier
    buffer_load_dwordx4 v50, s[52:55], s72 offen offset:0 lds
    s_add_u32 s98, s98, 131072
    s_and_b32 s98, s98, 917504
    s_add_u32 s100, s100, 1048576
    s_and_b32 s100, s100, 3145728
    s_add_u32 s101, s100, s78
    s_add_u32 s75, s98, s101
    buffer_load_dwordx4 v51, s[52:55], s72 offen offset:1024 lds
    buffer_load_dwordx4 v52, s[52:55], s72 offen offset:2048 lds
    buffer_load_dwordx4 v53, s[52:55], s72 offen offset:3072 lds
    s_add_u32 m0, s79, 16384
    s_waitcnt vmcnt(12)
    s_barrier
    buffer_load_dwordx4 v50, s[52:55], s75 offen offset:0 lds
    s_add_u32 s98, s98, 131072
    s_and_b32 s98, s98, 917504
    s_add_u32 s72, s98, s101
    buffer_load_dwordx4 v51, s[52:55], s75 offen offset:1024 lds
    buffer_load_dwordx4 v52, s[52:55], s75 offen offset:2048 lds
    buffer_load_dwordx4 v53, s[52:55], s75 offen offset:3072 lds
    s_add_u32 m0, s79, 24576
    s_waitcnt vmcnt(12)
    s_barrier
    buffer_load_dwordx4 v50, s[52:55], s72 offen offset:0 lds
    s_add_u32 s98, s98, 131072
    s_and_b32 s98, s98, 917504
    s_add_u32 s75, s98, s101
    buffer_load_dwordx4 v51, s[52:55], s72 offen offset:1024 lds
    buffer_load_dwordx4 v52, s[52:55], s72 offen offset:2048 lds
    buffer_load_dwordx4 v53, s[52:55], s72 offen offset:3072 lds
    s_add_u32 m0, s79, 32768
    s_waitcnt vmcnt(12)
    s_barrier
    buffer_load_dwordx4 v50, s[52:55], s75 offen offset:0 lds
    s_add_u32 s98, s98, 131072
    s_and_b32 s98, s98, 917504
    s_add_u32 s72, s98, s101
    buffer_load_dwordx4 v51, s[52:55], s75 offen offset:1024 lds
    buffer_load_dwordx4 v52, s[52:55], s75 offen offset:2048 lds
    buffer_load_dwordx4 v53, s[52:55], s75 offen offset:3072 lds
    s_add_u32 m0, s79, 40960
    s_waitcnt vmcnt(12)
    s_barrier
    buffer_load_dwordx4 v50, s[52:55], s72 offen offset:0 lds
    s_add_u32 s98, s98, 131072
    s_and_b32 s98, s98, 917504
    s_add_u32 s75, s98, s101
    buffer_load_dwordx4 v51, s[52:55], s72 offen offset:1024 lds
    buffer_load_dwordx4 v52, s[52:55], s72 offen offset:2048 lds
    buffer_load_dwordx4 v53, s[52:55], s72 offen offset:3072 lds
    s_add_u32 m0, s79, 0
    s_waitcnt vmcnt(12)
    s_barrier
    buffer_load_dwordx4 v50, s[52:55], s75 offen offset:0 lds
    s_add_u32 s98, s98, 131072
    s_and_b32 s98, s98, 917504
    s_add_u32 s72, s98, s101
    buffer_load_dwordx4 v51, s[52:55], s75 offen offset:1024 lds
    buffer_load_dwordx4 v52, s[52:55], s75 offen offset:2048 lds
    buffer_load_dwordx4 v53, s[52:55], s75 offen offset:3072 lds
    s_add_u32 m0, s79, 8192
    ds_write_b128 v63, v[192:195] offset:8192
    ds_write_b128 v63, v[196:199] offset:9216
    ds_write_b128 v63, v[200:203] offset:10240
    ds_write_b128 v63, v[204:207] offset:11264
    s_waitcnt vmcnt(12)
    s_barrier
    buffer_load_dwordx4 v50, s[52:55], s72 offen offset:0 lds
    s_add_u32 s98, s98, 131072
    s_and_b32 s98, s98, 917504
    s_add_u32 s75, s98, s101
    buffer_load_dwordx4 v51, s[52:55], s72 offen offset:1024 lds
    buffer_load_dwordx4 v52, s[52:55], s72 offen offset:2048 lds
    buffer_load_dwordx4 v53, s[52:55], s72 offen offset:3072 lds
    s_add_u32 m0, s79, 16384
    s_waitcnt vmcnt(12)
    s_barrier
    buffer_load_dwordx4 v50, s[52:55], s75 offen offset:0 lds
    s_add_u32 s98, s98, 131072
    s_and_b32 s98, s98, 917504
    s_add_u32 s72, s98, s101
    buffer_load_dwordx4 v51, s[52:55], s75 offen offset:1024 lds
    buffer_load_dwordx4 v52, s[52:55], s75 offen offset:2048 lds
    buffer_load_dwordx4 v53, s[52:55], s75 offen offset:3072 lds
    s_add_u32 m0, s79, 24576
    s_waitcnt vmcnt(12)
    s_barrier
    buffer_load_dwordx4 v50, s[52:55], s72 offen offset:0 lds
    s_add_u32 s98, s98, 131072
    s_and_b32 s98, s98, 917504
    s_add_u32 s100, s100, 1048576
    s_and_b32 s100, s100, 3145728
    s_add_u32 s101, s100, s78
    s_add_u32 s75, s98, s101
    buffer_load_dwordx4 v51, s[52:55], s72 offen offset:1024 lds
    buffer_load_dwordx4 v52, s[52:55], s72 offen offset:2048 lds
    buffer_load_dwordx4 v53, s[52:55], s72 offen offset:3072 lds
    s_add_u32 m0, s79, 32768
    s_waitcnt vmcnt(12)
    s_barrier
    buffer_load_dwordx4 v50, s[52:55], s75 offen offset:0 lds
    s_add_u32 s98, s98, 131072
    s_and_b32 s98, s98, 917504
    s_add_u32 s72, s98, s101
    buffer_load_dwordx4 v51, s[52:55], s75 offen offset:1024 lds
    buffer_load_dwordx4 v52, s[52:55], s75 offen offset:2048 lds
    buffer_load_dwordx4 v53, s[52:55], s75 offen offset:3072 lds
    s_add_u32 m0, s79, 40960
    s_waitcnt vmcnt(12)
    s_barrier
    buffer_load_dwordx4 v50, s[52:55], s72 offen offset:0 lds
    s_add_u32 s98, s98, 131072
    s_and_b32 s98, s98, 917504
    s_add_u32 s75, s98, s101
    buffer_load_dwordx4 v51, s[52:55], s72 offen offset:1024 lds
    buffer_load_dwordx4 v52, s[52:55], s72 offen offset:2048 lds
    buffer_load_dwordx4 v53, s[52:55], s72 offen offset:3072 lds
    s_add_u32 m0, s79, 0
    s_waitcnt vmcnt(12)
    s_barrier
    buffer_load_dwordx4 v50, s[52:55], s75 offen offset:0 lds
    s_add_u32 s98, s98, 131072
    s_and_b32 s98, s98, 917504
    s_add_u32 s72, s98, s101
    buffer_load_dwordx4 v51, s[52:55], s75 offen offset:1024 lds
    buffer_load_dwordx4 v52, s[52:55], s75 offen offset:2048 lds
    buffer_load_dwordx4 v53, s[52:55], s75 offen offset:3072 lds
    s_add_u32 m0, s79, 8192
    s_waitcnt vmcnt(12)
    s_barrier
    buffer_load_dwordx4 v50, s[52:55], s72 offen offset:0 lds
    s_add_u32 s98, s98, 131072
    s_and_b32 s98, s98, 917504
    s_add_u32 s75, s98, s101
    buffer_load_dwordx4 v51, s[52:55], s72 offen offset:1024 lds
    buffer_load_dwordx4 v52, s[52:55], s72 offen offset:2048 lds
    buffer_load_dwordx4 v53, s[52:55], s72 offen offset:3072 lds
    s_add_u32 m0, s79, 16384
    s_waitcnt vmcnt(12)
    s_barrier
    buffer_load_dwordx4 v50, s[52:55], s75 offen offset:0 lds
    s_add_u32 s98, s98, 131072
    s_and_b32 s98, s98, 917504
    s_add_u32 s72, s98, s101
    buffer_load_dwordx4 v51, s[52:55], s75 offen offset:1024 lds
    buffer_load_dwordx4 v52, s[52:55], s75 offen offset:2048 lds
    buffer_load_dwordx4 v53, s[52:55], s75 offen offset:3072 lds
    s_add_u32 m0, s79, 24576
    s_waitcnt vmcnt(12)
    s_barrier
    buffer_load_dwordx4 v50, s[52:55], s72 offen offset:0 lds
    s_add_u32 s98, s98, 131072
    s_and_b32 s98, s98, 917504
    s_add_u32 s75, s98, s101
    buffer_load_dwordx4 v51, s[52:55], s72 offen offset:1024 lds
    buffer_load_dwordx4 v52, s[52:55], s72 offen offset:2048 lds
    buffer_load_dwordx4 v53, s[52:55], s72 offen offset:3072 lds
    s_add_u32 m0, s79, 32768
    s_waitcnt vmcnt(12)
    s_barrier
    buffer_load_dwordx4 v50, s[52:55], s75 offen offset:0 lds
    s_add_u32 s98, s98, 131072
    s_and_b32 s98, s98, 917504
    s_add_u32 s72, s98, s101
    buffer_load_dwordx4 v51, s[52:55], s75 offen offset:1024 lds
    buffer_load_dwordx4 v52, s[52:55], s75 offen offset:2048 lds
    buffer_load_dwordx4 v53, s[52:55], s75 offen offset:3072 lds
    s_add_u32 m0, s79, 40960
    s_waitcnt vmcnt(12)
    s_barrier
    buffer_load_dwordx4 v50, s[52:55], s72 offen offset:0 lds
    s_xor_b32 s75, s96, 16384
    buffer_load_dwordx4 v51, s[52:55], s72 offen offset:1024 lds
    buffer_load_dwordx4 v52, s[52:55], s72 offen offset:2048 lds
    buffer_load_dwordx4 v53, s[52:55], s72 offen offset:3072 lds
    s_add_u32 m0, s99, 16384
    ds_write_b128 v62, v[128:131] offset:0
    ds_write_b128 v62, v[132:135] offset:1024
    ds_write_b128 v62, v[136:139] offset:2048
    ds_write_b128 v62, v[140:143] offset:3072
    s_waitcnt vmcnt(12)
    s_barrier
    buffer_load_dwordx4 v26, s[48:51], s75 offen offset:0 nt lds
    s_xor_b32 s72, s96, 32768
    buffer_load_dwordx4 v26, s[48:51], s75 offen offset:1024 nt lds
    buffer_load_dwordx4 v26, s[48:51], s75 offen offset:2048 nt lds
    buffer_load_dwordx4 v26, s[48:51], s75 offen offset:3072 nt lds
    s_add_u32 m0, s79, 32768
    ds_write_b128 v62, v[144:147] offset:8192
    ds_write_b128 v62, v[148:151] offset:9216
    ds_write_b128 v62, v[152:155] offset:10240
    ds_write_b128 v62, v[156:159] offset:11264
    s_waitcnt vmcnt(12)
    s_barrier
    ds_write_b128 v62, v[176:179] offset:16384
    ds_write_b128 v62, v[180:183] offset:17408
    ds_write_b128 v62, v[184:187] offset:18432
    ds_write_b128 v62, v[188:191] offset:19456
    s_waitcnt vmcnt(8)
    s_barrier
    ds_write_b128 v62, v[208:211] offset:24576
    ds_write_b128 v62, v[212:215] offset:25600
    ds_write_b128 v62, v[216:219] offset:26624
    ds_write_b128 v62, v[220:223] offset:27648
    s_waitcnt vmcnt(4)
    s_barrier
    buffer_load_dwordx4 v54, s[44:47], s72 offen offset:0 nt lds
    buffer_load_dwordx4 v55, s[44:47], s72 offen offset:1024 nt lds
    buffer_load_dwordx4 v56, s[44:47], s72 offen offset:2048 nt lds
    buffer_load_dwordx4 v57, s[44:47], s72 offen offset:3072 nt lds
    v_subrev_u32 v51, 7168, v51
    v_subrev_u32 v52, 14336, v52
    v_subrev_u32 v53, 21504, v53
    s_and_b32 s14, s3, 3
    s_lshl_b32 s14, s14, 12
    s_lshl_b32 s78, s4, 19
    s_add_u32 s78, s78, s14

    s_barrier
L_getq:
    s_waitcnt lgkmcnt(0)
    s_barrier
    ds_read_b128 v[160:163], v48 offset:0
    ds_read_b128 v[164:167], v48 offset:1024
    ds_read_b128 v[168:171], v48 offset:2048
    ds_read_b128 v[172:175], v48 offset:3072
    ds_read_b128 v[176:179], v48 offset:4096
    ds_read_b128 v[180:183], v48 offset:5120
    ds_read_b128 v[184:187], v48 offset:6144
    ds_read_b128 v[188:191], v48 offset:7168
    s_branch L_attn
L_cons:
    s_lshl_b32 s9, s9, 5
    s_mov_b32 s13, 0

    s_lshl_b32 s14, s2, 16
    s_lshl_b32 s15, s3, 14
    s_add_u32 s16, s14, s15
    s_add_u32 s17, s16, 4096
    s_add_u32 s18, s16, 8192
    s_add_u32 s19, s16, 12288
    s_mov_b32 s20, 1
    s_mov_b32 s22, -2

    s_lshl_b32 s35, s6, 7
    s_lshl_b32 s23, s7, 3
    s_add_u32 s35, s35, s23
    s_lshl_b32 s34, s2, 10
    s_add_u32 s34, s34, 0x1000000
    s_mov_b32 s24, s38
    s_mov_b32 s25, s39
    s_mov_b32 s26, 256
    s_mov_b32 s27, 0x00020000
    s_or_b32 s20, s10, s3
    s_cbranch_scc1 L_nc1
    v_mov_b32 v64, -1
    v_mov_b32 v65, -1
    v_mov_b32 v66, -1
    v_mov_b32 v67, -1
    buffer_store_dwordx4 v[64:67], v49, s[60:63], s34 offen sc1

L_nc1:
L_phase:
    s_mov_b32 s8, 0
    s_mov_b32 s11, 32768
    v_xor_b32 v11, s9, v10

    v_add_u32 v6, s11, v2
    v_add_u32 v7, s11, v3
    v_add_u32 v8, s11, v4
    v_add_u32 v9, s11, v5
    s_waitcnt vmcnt(0) lgkmcnt(0)
    s_barrier
    ds_read_b128 v[84:87], v11 offset:32768
    ds_read_b64_tr_b16 v[64:65], v6 offset:0
    ds_read_b64_tr_b16 v[66:67], v6 offset:4096
    ds_read_b128 v[80:83], v11 offset:0
    ds_read_b64_tr_b16 v[68:69], v7 offset:0
    ds_read_b64_tr_b16 v[70:71], v7 offset:4096
    ds_read_b64_tr_b16 v[72:73], v8 offset:0
    ds_read_b64_tr_b16 v[74:75], v8 offset:4096
    ds_read_b64_tr_b16 v[76:77], v9 offset:0
    ds_read_b64_tr_b16 v[78:79], v9 offset:4096
    s_cmp_eq_u32 s20, 0
    s_cbranch_scc1 L_ann
L_annr:
    s_waitcnt lgkmcnt(7)
    v_mfma_f32_32x32x16_bf16 v[128:143], v[64:67], v[84:87], 0
    s_add_u32 s8, s8, 32
    s_add_u32 s14, s8, s9
    s_and_b32 s14, s14, 0xe0
    s_lshl_b32 s15, s8, 5
    s_and_b32 s15, s15, 0x6000
    s_or_b32 s14, s14, s15

    s_waitcnt lgkmcnt(6)
    v_mfma_f32_32x32x16_bf16 v[192:207], v[64:67], v[80:83], 0
    s_add_u32 s11, s11, 8192
    s_cmp_eq_u32 s11, 49152
    s_cselect_b32 s11, 0, s11
    v_xor_b32 v11, s14, v10

    s_waitcnt lgkmcnt(4)
    v_mfma_f32_32x32x16_bf16 v[144:159], v[68:71], v[84:87], 0
    v_add_u32 v6, s11, v2
    v_add_u32 v7, s11, v3
    v_add_u32 v8, s11, v4
    v_add_u32 v9, s11, v5
    s_cmp_eq_u32 s8, 1024
    v_mfma_f32_32x32x16_bf16 v[208:223], v[68:71], v[80:83], 0
    s_waitcnt lgkmcnt(0)
    s_barrier
    v_mfma_f32_32x32x16_bf16 v[160:175], v[72:75], v[84:87], 0
    ds_read_b128 v[108:111], v11 offset:32768
    ds_read_b64_tr_b16 v[88:89], v6 offset:0
    ds_read_b64_tr_b16 v[90:91], v6 offset:4096
    ds_read_b128 v[104:107], v11 offset:0
    v_mfma_f32_32x32x16_bf16 v[176:191], v[76:79], v[84:87], 0
    ds_read_b64_tr_b16 v[92:93], v7 offset:0
    ds_read_b64_tr_b16 v[94:95], v7 offset:4096
    ds_read_b64_tr_b16 v[96:97], v8 offset:0
    ds_read_b64_tr_b16 v[98:99], v8 offset:4096
    v_mfma_f32_32x32x16_bf16 v[224:239], v[72:75], v[80:83], 0
    ds_read_b64_tr_b16 v[100:101], v9 offset:0
    ds_read_b64_tr_b16 v[102:103], v9 offset:4096
    v_mfma_f32_32x32x16_bf16 v[240:255], v[76:79], v[80:83], 0
L_cloop:
    s_waitcnt lgkmcnt(7)
    v_mfma_f32_32x32x16_bf16 v[128:143], v[88:91], v[108:111], v[128:143]
    s_add_u32 s8, s8, 32
    s_add_u32 s14, s8, s9
    s_and_b32 s14, s14, 0xe0
    s_lshl_b32 s15, s8, 5
    s_and_b32 s15, s15, 0x6000
    s_or_b32 s14, s14, s15

    s_waitcnt lgkmcnt(6)
    v_mfma_f32_32x32x16_bf16 v[192:207], v[88:91], v[104:107], v[192:207]
    s_add_u32 s11, s11, 8192
    s_cmp_eq_u32 s11, 49152
    s_cselect_b32 s11, 0, s11
    v_xor_b32 v11, s14, v10

    s_waitcnt lgkmcnt(4)
    v_mfma_f32_32x32x16_bf16 v[144:159], v[92:95], v[108:111], v[144:159]
    v_add_u32 v6, s11, v2
    v_add_u32 v7, s11, v3
    v_add_u32 v8, s11, v4
    v_add_u32 v9, s11, v5
    s_cmp_eq_u32 s8, 1024
    v_mfma_f32_32x32x16_bf16 v[208:223], v[92:95], v[104:107], v[208:223]
    s_waitcnt lgkmcnt(0)
    s_barrier
    s_cbranch_scc1 L_ctail
    v_mfma_f32_32x32x16_bf16 v[160:175], v[96:99], v[108:111], v[160:175]
    ds_read_b128 v[84:87], v11 offset:32768
    ds_read_b64_tr_b16 v[64:65], v6 offset:0
    ds_read_b64_tr_b16 v[66:67], v6 offset:4096
    ds_read_b128 v[80:83], v11 offset:0
    v_mfma_f32_32x32x16_bf16 v[176:191], v[100:103], v[108:111], v[176:191]
    ds_read_b64_tr_b16 v[68:69], v7 offset:0
    ds_read_b64_tr_b16 v[70:71], v7 offset:4096
    ds_read_b64_tr_b16 v[72:73], v8 offset:0
    ds_read_b64_tr_b16 v[74:75], v8 offset:4096
    v_mfma_f32_32x32x16_bf16 v[224:239], v[96:99], v[104:107], v[224:239]
    ds_read_b64_tr_b16 v[76:77], v9 offset:0
    ds_read_b64_tr_b16 v[78:79], v9 offset:4096
    v_mfma_f32_32x32x16_bf16 v[240:255], v[100:103], v[104:107], v[240:255]
    s_waitcnt lgkmcnt(7)
    v_mfma_f32_32x32x16_bf16 v[128:143], v[64:67], v[84:87], v[128:143]
    s_add_u32 s8, s8, 32
    s_add_u32 s14, s8, s9
    s_and_b32 s14, s14, 0xe0
    s_lshl_b32 s15, s8, 5
    s_and_b32 s15, s15, 0x6000
    s_or_b32 s14, s14, s15

    s_waitcnt lgkmcnt(6)
    v_mfma_f32_32x32x16_bf16 v[192:207], v[64:67], v[80:83], v[192:207]
    s_add_u32 s11, s11, 8192
    s_cmp_eq_u32 s11, 49152
    s_cselect_b32 s11, 0, s11
    v_xor_b32 v11, s14, v10

    s_waitcnt lgkmcnt(4)
    v_mfma_f32_32x32x16_bf16 v[144:159], v[68:71], v[84:87], v[144:159]
    v_add_u32 v6, s11, v2
    v_add_u32 v7, s11, v3
    v_add_u32 v8, s11, v4
    v_add_u32 v9, s11, v5
    s_cmp_eq_u32 s8, 1024
    v_mfma_f32_32x32x16_bf16 v[208:223], v[68:71], v[80:83], v[208:223]
    s_waitcnt lgkmcnt(0)
    s_barrier
    v_mfma_f32_32x32x16_bf16 v[160:175], v[72:75], v[84:87], v[160:175]
    ds_read_b128 v[108:111], v11 offset:32768
    ds_read_b64_tr_b16 v[88:89], v6 offset:0
    ds_read_b64_tr_b16 v[90:91], v6 offset:4096
    ds_read_b128 v[104:107], v11 offset:0
    v_mfma_f32_32x32x16_bf16 v[176:191], v[76:79], v[84:87], v[176:191]
    ds_read_b64_tr_b16 v[92:93], v7 offset:0
    ds_read_b64_tr_b16 v[94:95], v7 offset:4096
    ds_read_b64_tr_b16 v[96:97], v8 offset:0
    ds_read_b64_tr_b16 v[98:99], v8 offset:4096
    v_mfma_f32_32x32x16_bf16 v[224:239], v[72:75], v[80:83], v[224:239]
    ds_read_b64_tr_b16 v[100:101], v9 offset:0
    ds_read_b64_tr_b16 v[102:103], v9 offset:4096
    v_mfma_f32_32x32x16_bf16 v[240:255], v[76:79], v[80:83], v[240:255]
    s_branch L_cloop
L_ctail:
    v_mfma_f32_32x32x16_bf16 v[160:175], v[96:99], v[108:111], v[160:175]
    s_cmp_lg_u32 s13, 0
    s_cbranch_scc1 L_otail
    v_mfma_f32_32x32x16_bf16 v[176:191], v[100:103], v[108:111], v[176:191]
    v_mul_f32 v128, s76, v128
    v_mul_f32 v129, s76, v129
    v_mul_f32 v130, s76, v130
    v_mul_f32 v131, s76, v131
    v_mul_f32 v132, s76, v132
    v_mul_f32 v133, s76, v133
    v_mul_f32 v134, s76, v134
    v_mul_f32 v135, s76, v135
    v_mul_f32 v136, s76, v136
    v_mul_f32 v137, s76, v137
    v_mul_f32 v138, s76, v138
    v_mul_f32 v139, s76, v139
    v_mul_f32 v140, s76, v140
    v_mul_f32 v141, s76, v141
    v_mul_f32 v142, s76, v142
    v_mul_f32 v143, s76, v143
    v_cvt_pk_bf16_f32 v64, v128, v129
    v_cvt_pk_bf16_f32 v65, v130, v131
    v_cvt_pk_bf16_f32 v66, v132, v133
    v_cvt_pk_bf16_f32 v67, v134, v135
    v_cvt_pk_bf16_f32 v68, v136, v137
    v_cvt_pk_bf16_f32 v69, v138, v139
    v_cvt_pk_bf16_f32 v70, v140, v141
    v_cvt_pk_bf16_f32 v71, v142, v143
    ds_write_b128 v48, v[64:67] offset:0
    ds_write_b128 v48, v[68:71] offset:1024
    v_mfma_f32_32x32x16_bf16 v[224:239], v[96:99], v[104:107], v[224:239]
    v_mul_f32 v144, s76, v144
    v_mul_f32 v145, s76, v145
    v_mul_f32 v146, s76, v146
    v_mul_f32 v147, s76, v147
    v_mul_f32 v148, s76, v148
    v_mul_f32 v149, s76, v149
    v_mul_f32 v150, s76, v150
    v_mul_f32 v151, s76, v151
    v_mul_f32 v152, s76, v152
    v_mul_f32 v153, s76, v153
    v_mul_f32 v154, s76, v154
    v_mul_f32 v155, s76, v155
    v_mul_f32 v156, s76, v156
    v_mul_f32 v157, s76, v157
    v_mul_f32 v158, s76, v158
    v_mul_f32 v159, s76, v159
    v_cvt_pk_bf16_f32 v72, v144, v145
    v_cvt_pk_bf16_f32 v73, v146, v147
    v_cvt_pk_bf16_f32 v74, v148, v149
    v_cvt_pk_bf16_f32 v75, v150, v151
    v_cvt_pk_bf16_f32 v76, v152, v153
    v_cvt_pk_bf16_f32 v77, v154, v155
    v_cvt_pk_bf16_f32 v78, v156, v157
    v_cvt_pk_bf16_f32 v79, v158, v159
    ds_write_b128 v48, v[72:75] offset:2048
    ds_write_b128 v48, v[76:79] offset:3072
    v_mfma_f32_32x32x16_bf16 v[240:255], v[100:103], v[104:107], v[240:255]
    v_mul_f32 v160, s76, v160
    v_mul_f32 v161, s76, v161
    v_mul_f32 v162, s76, v162
    v_mul_f32 v163, s76, v163
    v_mul_f32 v164, s76, v164
    v_mul_f32 v165, s76, v165
    v_mul_f32 v166, s76, v166
    v_mul_f32 v167, s76, v167
    v_mul_f32 v168, s76, v168
    v_mul_f32 v169, s76, v169
    v_mul_f32 v170, s76, v170
    v_mul_f32 v171, s76, v171
    v_mul_f32 v172, s76, v172
    v_mul_f32 v173, s76, v173
    v_mul_f32 v174, s76, v174
    v_mul_f32 v175, s76, v175
    v_cvt_pk_bf16_f32 v80, v160, v161
    v_cvt_pk_bf16_f32 v81, v162, v163
    v_cvt_pk_bf16_f32 v82, v164, v165
    v_cvt_pk_bf16_f32 v83, v166, v167
    v_cvt_pk_bf16_f32 v84, v168, v169
    v_cvt_pk_bf16_f32 v85, v170, v171
    v_cvt_pk_bf16_f32 v86, v172, v173
    v_cvt_pk_bf16_f32 v87, v174, v175
    ds_write_b128 v48, v[80:83] offset:4096
    ds_write_b128 v48, v[84:87] offset:5120
    v_mul_f32 v176, s76, v176
    v_mul_f32 v177, s76, v177
    v_mul_f32 v178, s76, v178
    v_mul_f32 v179, s76, v179
    v_mul_f32 v180, s76, v180
    v_mul_f32 v181, s76, v181
    v_mul_f32 v182, s76, v182
    v_mul_f32 v183, s76, v183
    v_mul_f32 v184, s76, v184
    v_mul_f32 v185, s76, v185
    v_mul_f32 v186, s76, v186
    v_mul_f32 v187, s76, v187
    v_mul_f32 v188, s76, v188
    v_mul_f32 v189, s76, v189
    v_mul_f32 v190, s76, v190
    v_mul_f32 v191, s76, v191
    v_cvt_pk_bf16_f32 v112, v176, v177
    v_cvt_pk_bf16_f32 v113, v178, v179
    v_cvt_pk_bf16_f32 v114, v180, v181
    v_cvt_pk_bf16_f32 v115, v182, v183
    v_cvt_pk_bf16_f32 v116, v184, v185
    v_cvt_pk_bf16_f32 v117, v186, v187
    v_cvt_pk_bf16_f32 v118, v188, v189
    v_cvt_pk_bf16_f32 v119, v190, v191
    ds_write_b128 v48, v[112:115] offset:6144
    ds_write_b128 v48, v[116:119] offset:7168
    s_waitcnt lgkmcnt(0)
    s_barrier
    v_mul_f32 v192, s76, v192
    v_mul_f32 v193, s76, v193
    v_mul_f32 v194, s76, v194
    v_mul_f32 v195, s76, v195
    v_mul_f32 v196, s76, v196
    v_mul_f32 v197, s76, v197
    v_mul_f32 v198, s76, v198
    v_mul_f32 v199, s76, v199
    v_mul_f32 v200, s76, v200
    v_mul_f32 v201, s76, v201
    v_mul_f32 v202, s76, v202
    v_mul_f32 v203, s76, v203
    v_mul_f32 v204, s76, v204
    v_mul_f32 v205, s76, v205
    v_mul_f32 v206, s76, v206
    v_mul_f32 v207, s76, v207
    v_cvt_pk_bf16_f32 v160, v192, v193
    v_cvt_pk_bf16_f32 v161, v194, v195
    v_cvt_pk_bf16_f32 v162, v196, v197
    v_cvt_pk_bf16_f32 v163, v198, v199
    v_cvt_pk_bf16_f32 v164, v200, v201
    v_cvt_pk_bf16_f32 v165, v202, v203
    v_cvt_pk_bf16_f32 v166, v204, v205
    v_cvt_pk_bf16_f32 v167, v206, v207
    v_mul_f32 v208, s76, v208
    v_mul_f32 v209, s76, v209
    v_mul_f32 v210, s76, v210
    v_mul_f32 v211, s76, v211
    v_mul_f32 v212, s76, v212
    v_mul_f32 v213, s76, v213
    v_mul_f32 v214, s76, v214
    v_mul_f32 v215, s76, v215
    v_mul_f32 v216, s76, v216
    v_mul_f32 v217, s76, v217
    v_mul_f32 v218, s76, v218
    v_mul_f32 v219, s76, v219
    v_mul_f32 v220, s76, v220
    v_mul_f32 v221, s76, v221
    v_mul_f32 v222, s76, v222
    v_mul_f32 v223, s76, v223
    v_cvt_pk_bf16_f32 v168, v208, v209
    v_cvt_pk_bf16_f32 v169, v210, v211
    v_cvt_pk_bf16_f32 v170, v212, v213
    v_cvt_pk_bf16_f32 v171, v214, v215
    v_cvt_pk_bf16_f32 v172, v216, v217
    v_cvt_pk_bf16_f32 v173, v218, v219
    v_cvt_pk_bf16_f32 v174, v220, v221
    v_cvt_pk_bf16_f32 v175, v222, v223
    v_mul_f32 v224, s76, v224
    v_mul_f32 v225, s76, v225
    v_mul_f32 v226, s76, v226
    v_mul_f32 v227, s76, v227
    v_mul_f32 v228, s76, v228
    v_mul_f32 v229, s76, v229
    v_mul_f32 v230, s76, v230
    v_mul_f32 v231, s76, v231
    v_mul_f32 v232, s76, v232
    v_mul_f32 v233, s76, v233
    v_mul_f32 v234, s76, v234
    v_mul_f32 v235, s76, v235
    v_mul_f32 v236, s76, v236
    v_mul_f32 v237, s76, v237
    v_mul_f32 v238, s76, v238
    v_mul_f32 v239, s76, v239
    v_cvt_pk_bf16_f32 v176, v224, v225
    v_cvt_pk_bf16_f32 v177, v226, v227
    v_cvt_pk_bf16_f32 v178, v228, v229
    v_cvt_pk_bf16_f32 v179, v230, v231
    v_cvt_pk_bf16_f32 v180, v232, v233
    v_cvt_pk_bf16_f32 v181, v234, v235
    v_cvt_pk_bf16_f32 v182, v236, v237
    v_cvt_pk_bf16_f32 v183, v238, v239
    v_mul_f32 v240, s76, v240
    v_mul_f32 v241, s76, v241
    v_mul_f32 v242, s76, v242
    v_mul_f32 v243, s76, v243
    v_mul_f32 v244, s76, v244
    v_mul_f32 v245, s76, v245
    v_mul_f32 v246, s76, v246
    v_mul_f32 v247, s76, v247
    v_mul_f32 v248, s76, v248
    v_mul_f32 v249, s76, v249
    v_mul_f32 v250, s76, v250
    v_mul_f32 v251, s76, v251
    v_mul_f32 v252, s76, v252
    v_mul_f32 v253, s76, v253
    v_mul_f32 v254, s76, v254
    v_mul_f32 v255, s76, v255
    v_cvt_pk_bf16_f32 v184, v240, v241
    v_cvt_pk_bf16_f32 v185, v242, v243
    v_cvt_pk_bf16_f32 v186, v244, v245
    v_cvt_pk_bf16_f32 v187, v246, v247
    v_cvt_pk_bf16_f32 v188, v248, v249
    v_cvt_pk_bf16_f32 v189, v250, v251
    v_cvt_pk_bf16_f32 v190, v252, v253
    v_cvt_pk_bf16_f32 v191, v254, v255
    s_mov_b32 s13, 1
    s_lshr_b32 s9, s9, 5

L_attn:

    s_lshl_b32 s21, s6, 7
    s_lshl_b32 s23, s7, 3
    s_add_u32 s21, s21, s23
    s_lshr_b32 s23, s4, 1
    s_mov_b32 s35, s21
    s_lshl_b32 s34, s2, 10
    s_add_u32 s34, s34, 0x1000000
    s_xor_b32 s21, s21, 128
    s_mov_b32 s24, s38
    s_mov_b32 s25, s39
    s_mov_b32 s26, 256
    s_mov_b32 s27, 0x00020000
    s_and_b32 s28, s2, 0xf8
    s_xor_b32 s28, s28, 9
    s_lshl_b32 s28, s28, 3
    s_add_u32 s28, s28, s4
    s_lshl_b32 s28, s28, 1
    s_and_b32 s23, s3, 3
    s_add_u32 s28, s28, s23
    s_lshl_b32 s28, s28, 12
    s_add_u32 s29, s28, 0x20000
    s_add_u32 s30, s28, 0x40000
    s_add_u32 s31, s28, 0x60000
    v_mov_b32 v6, -1
    v_mov_b32 v7, -1
    v_mov_b32 v8, -1
    v_mov_b32 v9, -1

    ds_read_b128 v[224:227], v12 offset:0
    ds_read_b128 v[228:231], v13 offset:0
    ds_read_b128 v[232:235], v14 offset:0
    ds_read_b128 v[236:239], v15 offset:0
    ds_read_b128 v[240:243], v16 offset:0
    ds_read_b128 v[244:247], v17 offset:0
    ds_read_b128 v[248:251], v18 offset:0
    ds_read_b128 v[252:255], v19 offset:0
    s_waitcnt lgkmcnt(7)
    v_mfma_f32_32x32x16_bf16 v[128:143], v[224:227], v[160:163], 0
    s_cmp_lg_u32 s10, 0
    s_cbranch_scc1 L_ret0_0
    s_add_u32 m0, s69, 24576
    s_xor_b32 s75, s68, 24576
    buffer_load_dwordx4 v24, s[44:47], s75 offen offset:0 nt lds
    buffer_load_dwordx4 v25, s[44:47], s75 offen offset:1024 nt lds
L_ret0_0:
    s_waitcnt lgkmcnt(6)
    v_mfma_f32_32x32x16_bf16 v[128:143], v[228:231], v[164:167], v[128:143]
    s_waitcnt lgkmcnt(5)
    v_mfma_f32_32x32x16_bf16 v[128:143], v[232:235], v[168:171], v[128:143]
    s_cmp_lg_u32 s10, 0
    s_cbranch_scc1 L_ret0_1
    s_add_u32 m0, s70, 8192
    s_xor_b32 s75, s68, 8192
    buffer_load_dwordx4 v26, s[48:51], s75 offen offset:0 nt lds
    buffer_load_dwordx4 v26, s[48:51], s75 offen offset:1024 nt lds
L_ret0_1:
    s_waitcnt lgkmcnt(4)
    v_mfma_f32_32x32x16_bf16 v[128:143], v[236:239], v[172:175], v[128:143]
    s_waitcnt vmcnt(12) lgkmcnt(0)
    s_barrier
    ds_read_b128 v[224:227], v12 offset:8192
    ds_read_b128 v[228:231], v13 offset:8192
    ds_read_b128 v[232:235], v14 offset:8192
    v_mfma_f32_32x32x16_bf16 v[128:143], v[240:243], v[176:179], v[128:143]
    ds_read_b128 v[236:239], v15 offset:8192
    s_cmp_lg_u32 s10, 0
    s_cbranch_scc1 L_alt1_0
    s_add_u32 m0, s69, 32768
    s_xor_b32 s75, s68, 32768
    buffer_load_dwordx4 v24, s[44:47], s75 offen offset:0 nt lds
    buffer_load_dwordx4 v25, s[44:47], s75 offen offset:1024 nt lds
L_ret1_0:
    v_mfma_f32_32x32x16_bf16 v[128:143], v[244:247], v[180:183], v[128:143]
    ds_read_b128 v[240:243], v16 offset:8192
    v_mfma_f32_32x32x16_bf16 v[128:143], v[248:251], v[184:187], v[128:143]
    ds_read_b128 v[244:247], v17 offset:8192
    s_cmp_lg_u32 s10, 0
    s_cbranch_scc1 L_alt1_1
    s_add_u32 m0, s70, 16384
    s_xor_b32 s75, s68, 16384
    buffer_load_dwordx4 v26, s[48:51], s75 offen offset:0 nt lds
    buffer_load_dwordx4 v26, s[48:51], s75 offen offset:1024 nt lds
L_ret1_1:
    v_mfma_f32_32x32x16_bf16 v[128:143], v[252:255], v[188:191], v[128:143]
    ds_read_b128 v[248:251], v18 offset:8192
    s_nop 10
    v_max3_f32 v40, v128, v129, v130
    v_max3_f32 v41, v131, v132, v133
    v_max3_f32 v40, v40, v134, v135
    v_max3_f32 v41, v41, v136, v137
    v_max3_f32 v40, v40, v138, v139
    v_max3_f32 v41, v41, v140, v141
    v_max3_f32 v40, v40, v142, v143
    v_max_f32 v40, v40, v41
    v_mov_b32 v41, v40
    s_nop 1
    v_permlane32_swap_b32 v40, v41
    v_max_f32 v40, v40, v41
    v_sub_f32 v192, 0, v40
    v_mov_b32 v193, v192
    v_mov_b32 v194, v192
    v_mov_b32 v195, v192
    v_mov_b32 v196, v192
    v_mov_b32 v197, v192
    v_mov_b32 v198, v192
    v_mov_b32 v199, v192
    v_mov_b32 v200, v192
    v_mov_b32 v201, v192
    v_mov_b32 v202, v192
    v_mov_b32 v203, v192
    v_mov_b32 v204, v192
    v_mov_b32 v205, v192
    v_mov_b32 v206, v192
    v_mov_b32 v207, v192
    s_waitcnt lgkmcnt(6)
    s_nop 0
    v_mfma_f32_32x32x16_bf16 v[144:159], v[224:227], v[160:163], v[192:207]
    ds_read_b128 v[252:255], v19 offset:8192
    s_cmp_lg_u32 s10, 0
    s_cbranch_scc1 L_alt1_2
    s_add_u32 m0, s69, 40960
    s_xor_b32 s75, s68, 40960
    buffer_load_dwordx4 v24, s[44:47], s75 offen offset:0 nt lds
    buffer_load_dwordx4 v25, s[44:47], s75 offen offset:1024 nt lds
L_ret1_2:
    v_add_f32 v128, v128, v192
    v_add_f32 v129, v129, v192
    v_exp_f32 v32, v128
    v_exp_f32 v33, v129
    v_add_f32 v130, v130, v192
    v_add_f32 v131, v131, v192
    s_waitcnt lgkmcnt(6)
    v_mfma_f32_32x32x16_bf16 v[144:159], v[228:231], v[164:167], v[144:159]
    v_exp_f32 v34, v130
    v_exp_f32 v35, v131
    v_cvt_pk_bf16_f32 v208, v32, v33
    v_add_f32 v132, v132, v192
    v_add_f32 v133, v133, v192
    v_exp_f32 v36, v132
    v_exp_f32 v37, v133
    s_waitcnt lgkmcnt(5)
    v_mfma_f32_32x32x16_bf16 v[144:159], v[232:235], v[168:171], v[144:159]
    v_add_f32 v30, v32, v34
    v_add_f32 v31, v33, v35
    v_cvt_pk_bf16_f32 v209, v34, v35
    v_add_f32 v134, v134, v192
    v_add_f32 v135, v135, v192
    v_exp_f32 v38, v134
    v_exp_f32 v39, v135
    s_waitcnt lgkmcnt(4)
    v_mfma_f32_32x32x16_bf16 v[144:159], v[236:239], v[172:175], v[144:159]
    v_add_f32 v30, v30, v36
    v_add_f32 v31, v31, v37
    v_cvt_pk_bf16_f32 v210, v36, v37
    v_add_f32 v136, v136, v192
    v_add_f32 v137, v137, v192
    v_exp_f32 v32, v136
    v_exp_f32 v33, v137
    s_waitcnt vmcnt(10) lgkmcnt(0)
    s_barrier
    ds_read_b128 v[224:227], v12 offset:16384
    ds_read_b128 v[228:231], v13 offset:16384
    ds_read_b128 v[232:235], v14 offset:16384
    v_mfma_f32_32x32x16_bf16 v[144:159], v[240:243], v[176:179], v[144:159]
    ds_read_b128 v[236:239], v15 offset:16384
    s_cmp_lg_u32 s10, 0
    s_cbranch_scc1 L_alt2_0
    s_add_u32 m0, s70, 24576
    s_xor_b32 s75, s68, 24576
    buffer_load_dwordx4 v26, s[48:51], s75 offen offset:0 nt lds
    buffer_load_dwordx4 v26, s[48:51], s75 offen offset:1024 nt lds
L_ret2_0:
    v_add_f32 v30, v30, v38
    v_add_f32 v31, v31, v39
    v_cvt_pk_bf16_f32 v211, v38, v39
    v_add_f32 v138, v138, v192
    v_add_f32 v139, v139, v192
    v_exp_f32 v34, v138
    v_exp_f32 v35, v139
    v_mfma_f32_32x32x16_bf16 v[144:159], v[244:247], v[180:183], v[144:159]
    ds_read_b128 v[240:243], v16 offset:16384
    v_add_f32 v30, v30, v32
    v_add_f32 v31, v31, v33
    v_cvt_pk_bf16_f32 v212, v32, v33
    v_add_f32 v140, v140, v192
    v_add_f32 v141, v141, v192
    v_exp_f32 v36, v140
    v_exp_f32 v37, v141
    v_mfma_f32_32x32x16_bf16 v[144:159], v[248:251], v[184:187], v[144:159]
    ds_read_b128 v[244:247], v17 offset:16384
    s_cmp_lg_u32 s10, 0
    s_cbranch_scc1 L_ret2_1
    s_add_u32 m0, s69, 0
    s_xor_b32 s75, s68, 49152
    buffer_load_dwordx4 v24, s[44:47], s75 offen offset:0 nt lds
    buffer_load_dwordx4 v25, s[44:47], s75 offen offset:1024 nt lds
L_ret2_1:
    v_add_f32 v30, v30, v34
    v_add_f32 v31, v31, v35
    v_cvt_pk_bf16_f32 v213, v34, v35
    v_add_f32 v142, v142, v192
    v_add_f32 v143, v143, v192
    v_exp_f32 v38, v142
    v_exp_f32 v39, v143
    v_mfma_f32_32x32x16_bf16 v[144:159], v[252:255], v[188:191], v[144:159]
    ds_read_b128 v[248:251], v18 offset:16384
    v_add_f32 v30, v30, v36
    v_add_f32 v31, v31, v37
    v_cvt_pk_bf16_f32 v214, v36, v37
    v_add_f32 v30, v30, v38
    v_add_f32 v31, v31, v39
    v_cvt_pk_bf16_f32 v215, v38, v39
    v_add_f32 v30, v30, v31
    v_mov_b32 v29, v30
    s_waitcnt lgkmcnt(6)
    v_mfma_f32_32x32x16_bf16 v[128:143], v[224:227], v[160:163], v[192:207]
    ds_read_b128 v[252:255], v19 offset:16384
    s_cmp_lg_u32 s10, 0
    s_cbranch_scc1 L_ret2_2
    s_add_u32 m0, s69, 8192
    s_xor_b32 s75, s68, 57344
    buffer_load_dwordx4 v24, s[44:47], s75 offen offset:0 nt lds
    buffer_load_dwordx4 v25, s[44:47], s75 offen offset:1024 nt lds
L_ret2_2:
    s_waitcnt lgkmcnt(6)
    v_mfma_f32_32x32x16_bf16 v[128:143], v[228:231], v[164:167], v[128:143]
    ds_read_b64_tr_b16 v[224:225], v20 offset:0
    ds_read_b64_tr_b16 v[226:227], v20 offset:2048
    v_exp_f32 v32, v144
    v_exp_f32 v33, v145
    s_waitcnt lgkmcnt(7)
    v_mfma_f32_32x32x16_bf16 v[128:143], v[232:235], v[168:171], v[128:143]
    ds_read_b64_tr_b16 v[228:229], v21 offset:0
    ds_read_b64_tr_b16 v[230:231], v21 offset:2048
    v_exp_f32 v34, v146
    v_exp_f32 v35, v147
    v_cvt_pk_bf16_f32 v216, v32, v33
    s_waitcnt lgkmcnt(8)
    v_mfma_f32_32x32x16_bf16 v[128:143], v[236:239], v[172:175], v[128:143]
    ds_read_b64_tr_b16 v[232:233], v22 offset:0
    ds_read_b64_tr_b16 v[234:235], v22 offset:2048
    v_exp_f32 v36, v148
    v_exp_f32 v37, v149
    s_waitcnt lgkmcnt(9)
    v_mfma_f32_32x32x16_bf16 v[128:143], v[240:243], v[176:179], v[128:143]
    ds_read_b64_tr_b16 v[236:237], v23 offset:0
    ds_read_b64_tr_b16 v[238:239], v23 offset:2048
    v_add_f32 v30, v32, v34
    v_add_f32 v31, v33, v35
    v_cvt_pk_bf16_f32 v217, v34, v35
    s_waitcnt lgkmcnt(10)
    v_mfma_f32_32x32x16_bf16 v[128:143], v[244:247], v[180:183], v[128:143]
    ds_read_b64_tr_b16 v[240:241], v20 offset:4096
    ds_read_b64_tr_b16 v[242:243], v20 offset:6144
    v_exp_f32 v38, v150
    v_exp_f32 v39, v151
    v_add_f32 v30, v30, v36
    s_waitcnt lgkmcnt(11)
    v_mfma_f32_32x32x16_bf16 v[128:143], v[248:251], v[184:187], v[128:143]
    ds_read_b64_tr_b16 v[244:245], v21 offset:4096
    ds_read_b64_tr_b16 v[246:247], v21 offset:6144
    v_add_f32 v31, v31, v37
    v_cvt_pk_bf16_f32 v218, v36, v37
    s_waitcnt lgkmcnt(12)
    v_mfma_f32_32x32x16_bf16 v[128:143], v[252:255], v[188:191], v[128:143]
    ds_read_b64_tr_b16 v[248:249], v22 offset:4096
    ds_read_b64_tr_b16 v[250:251], v22 offset:6144
    v_exp_f32 v32, v152
    v_exp_f32 v33, v153
    v_add_f32 v30, v30, v38
    s_waitcnt lgkmcnt(12)
    v_mfma_f32_32x32x16_bf16 v[64:79], v[224:227], v[208:211], 0
    ds_read_b64_tr_b16 v[252:253], v23 offset:4096
    ds_read_b64_tr_b16 v[254:255], v23 offset:6144
    v_add_f32 v31, v31, v39
    v_cvt_pk_bf16_f32 v219, v38, v39
    s_waitcnt lgkmcnt(12)
    v_mfma_f32_32x32x16_bf16 v[80:95], v[228:231], v[208:211], 0
    v_exp_f32 v34, v154
    v_exp_f32 v35, v155
    v_add_f32 v30, v30, v32
    s_waitcnt lgkmcnt(10)
    v_mfma_f32_32x32x16_bf16 v[96:111], v[232:235], v[208:211], 0
    v_add_f32 v31, v31, v33
    v_cvt_pk_bf16_f32 v220, v32, v33
    v_exp_f32 v36, v156
    s_waitcnt lgkmcnt(8)
    v_mfma_f32_32x32x16_bf16 v[112:127], v[236:239], v[208:211], 0
    v_exp_f32 v37, v157
    v_add_f32 v30, v30, v34
    s_waitcnt vmcnt(12) lgkmcnt(0)
    s_barrier
    ds_read_b128 v[224:227], v12 offset:24576
    ds_read_b128 v[228:231], v13 offset:24576
    ds_read_b128 v[232:235], v14 offset:24576
    v_mfma_f32_32x32x16_bf16 v[64:79], v[240:243], v[212:215], v[64:79]
    ds_read_b128 v[236:239], v15 offset:24576
    s_add_u32 m0, s70, 0
    s_xor_b32 s75, s68, 32768
    buffer_load_dwordx4 v26, s[48:51], s75 offen offset:0 nt lds
    v_add_f32 v31, v31, v35
    v_cvt_pk_bf16_f32 v221, v34, v35
    v_exp_f32 v38, v158
    v_mfma_f32_32x32x16_bf16 v[80:95], v[244:247], v[212:215], v[80:95]
    ds_read_b128 v[240:243], v16 offset:24576
    buffer_load_dwordx4 v26, s[48:51], s75 offen offset:1024 nt lds
    v_exp_f32 v39, v159
    v_add_f32 v30, v30, v36
    v_mfma_f32_32x32x16_bf16 v[96:111], v[248:251], v[212:215], v[96:111]
    ds_read_b128 v[244:247], v17 offset:24576
    s_cmp_lg_u32 s10, 0
    s_cbranch_scc1 L_retk2
    s_add_u32 m0, s69, 16384
    s_xor_b32 s75, s68, 65536
    buffer_load_dwordx4 v24, s[44:47], s75 offen offset:0 nt lds
    buffer_load_dwordx4 v25, s[44:47], s75 offen offset:1024 nt lds
L_retk2:
    v_add_f32 v31, v31, v37
    v_cvt_pk_bf16_f32 v222, v36, v37
    v_add_f32 v30, v30, v38
    v_mfma_f32_32x32x16_bf16 v[112:127], v[252:255], v[212:215], v[112:127]
    ds_read_b128 v[248:251], v18 offset:24576
    v_add_f32 v31, v31, v39
    v_cvt_pk_bf16_f32 v223, v38, v39
    v_add_f32 v30, v30, v31
    s_mov_b32 s72, 1
    v_cmp_nge_f32 vcc, s71, v30
    s_cbranch_vccnz L_slow1
L_back1:
    v_add_f32 v29, v29, v30
    s_waitcnt lgkmcnt(6)
    v_mfma_f32_32x32x16_bf16 v[144:159], v[224:227], v[160:163], v[192:207]
    ds_read_b128 v[252:255], v19 offset:24576
    v_exp_f32 v32, v128
    v_exp_f32 v33, v129
    s_waitcnt lgkmcnt(6)
    v_mfma_f32_32x32x16_bf16 v[144:159], v[228:231], v[164:167], v[144:159]
    ds_read_b64_tr_b16 v[224:225], v20 offset:8192
    ds_read_b64_tr_b16 v[226:227], v20 offset:10240
    v_exp_f32 v34, v130
    v_exp_f32 v35, v131
    s_waitcnt lgkmcnt(7)
    v_mfma_f32_32x32x16_bf16 v[144:159], v[232:235], v[168:171], v[144:159]
    ds_read_b64_tr_b16 v[228:229], v21 offset:8192
    ds_read_b64_tr_b16 v[230:231], v21 offset:10240
    v_cvt_pk_bf16_f32 v208, v32, v33
    v_exp_f32 v36, v132
    v_exp_f32 v37, v133
    s_waitcnt lgkmcnt(8)
    v_mfma_f32_32x32x16_bf16 v[144:159], v[236:239], v[172:175], v[144:159]
    ds_read_b64_tr_b16 v[232:233], v22 offset:8192
    ds_read_b64_tr_b16 v[234:235], v22 offset:10240
    v_add_f32 v30, v32, v34
    v_add_f32 v31, v33, v35
    s_waitcnt lgkmcnt(9)
    v_mfma_f32_32x32x16_bf16 v[144:159], v[240:243], v[176:179], v[144:159]
    ds_read_b64_tr_b16 v[236:237], v23 offset:8192
    ds_read_b64_tr_b16 v[238:239], v23 offset:10240
    v_cvt_pk_bf16_f32 v209, v34, v35
    v_exp_f32 v38, v134
    v_exp_f32 v39, v135
    s_waitcnt lgkmcnt(10)
    v_mfma_f32_32x32x16_bf16 v[144:159], v[244:247], v[180:183], v[144:159]
    ds_read_b64_tr_b16 v[240:241], v20 offset:12288
    ds_read_b64_tr_b16 v[242:243], v20 offset:14336
    v_add_f32 v30, v30, v36
    v_add_f32 v31, v31, v37
    s_waitcnt lgkmcnt(11)
    v_mfma_f32_32x32x16_bf16 v[144:159], v[248:251], v[184:187], v[144:159]
    ds_read_b64_tr_b16 v[244:245], v21 offset:12288
    ds_read_b64_tr_b16 v[246:247], v21 offset:14336
    v_cvt_pk_bf16_f32 v210, v36, v37
    v_exp_f32 v32, v136
    v_exp_f32 v33, v137
    s_waitcnt lgkmcnt(12)
    v_mfma_f32_32x32x16_bf16 v[144:159], v[252:255], v[188:191], v[144:159]
    ds_read_b64_tr_b16 v[248:249], v22 offset:12288
    ds_read_b64_tr_b16 v[250:251], v22 offset:14336
    v_add_f32 v30, v30, v38
    v_add_f32 v31, v31, v39
    s_waitcnt lgkmcnt(12)
    v_mfma_f32_32x32x16_bf16 v[64:79], v[224:227], v[216:219], v[64:79]
    ds_read_b64_tr_b16 v[252:253], v23 offset:12288
    ds_read_b64_tr_b16 v[254:255], v23 offset:14336
    v_cvt_pk_bf16_f32 v211, v38, v39
    v_exp_f32 v34, v138
    s_waitcnt lgkmcnt(12)
    v_mfma_f32_32x32x16_bf16 v[80:95], v[228:231], v[216:219], v[80:95]
    v_exp_f32 v35, v139
    v_add_f32 v30, v30, v32
    v_add_f32 v31, v31, v33
    s_waitcnt lgkmcnt(10)
    v_mfma_f32_32x32x16_bf16 v[96:111], v[232:235], v[216:219], v[96:111]
    v_cvt_pk_bf16_f32 v212, v32, v33
    v_exp_f32 v36, v140
    s_waitcnt lgkmcnt(8)
    v_mfma_f32_32x32x16_bf16 v[112:127], v[236:239], v[216:219], v[112:127]
    v_exp_f32 v37, v141
    v_add_f32 v30, v30, v34
    v_add_f32 v31, v31, v35
    s_cmp_eq_u32 s10, 0
    s_cbranch_scc1 L_bw3
    s_waitcnt vmcnt(2)
L_bw3:
    s_waitcnt vmcnt(12) lgkmcnt(0)
    s_barrier
    ds_read_b128 v[224:227], v12 offset:32768
    ds_read_b128 v[228:231], v13 offset:32768
    ds_read_b128 v[232:235], v14 offset:32768
    v_mfma_f32_32x32x16_bf16 v[64:79], v[240:243], v[220:223], v[64:79]
    ds_read_b128 v[236:239], v15 offset:32768
    s_add_u32 m0, s70, 8192
    s_xor_b32 s75, s68, 40960
    buffer_load_dwordx4 v26, s[48:51], s75 offen offset:0 nt lds
    v_cvt_pk_bf16_f32 v213, v34, v35
    v_exp_f32 v38, v142
    v_mfma_f32_32x32x16_bf16 v[80:95], v[244:247], v[220:223], v[80:95]
    ds_read_b128 v[240:243], v16 offset:32768
    buffer_load_dwordx4 v26, s[48:51], s75 offen offset:1024 nt lds
    v_exp_f32 v39, v143
    v_add_f32 v30, v30, v36
    v_add_f32 v31, v31, v37
    v_mfma_f32_32x32x16_bf16 v[96:111], v[248:251], v[220:223], v[96:111]
    ds_read_b128 v[244:247], v17 offset:32768
    s_cmp_lg_u32 s10, 0
    s_cbranch_scc1 L_retk3
    s_add_u32 m0, s69, 24576
    s_xor_b32 s75, s68, 73728
    buffer_load_dwordx4 v24, s[44:47], s75 offen offset:0 nt lds
    buffer_load_dwordx4 v25, s[44:47], s75 offen offset:1024 nt lds
L_retk3:
    v_cvt_pk_bf16_f32 v214, v36, v37
    v_add_f32 v30, v30, v38
    v_mfma_f32_32x32x16_bf16 v[112:127], v[252:255], v[220:223], v[112:127]
    ds_read_b128 v[248:251], v18 offset:32768
    v_add_f32 v31, v31, v39
    v_cvt_pk_bf16_f32 v215, v38, v39
    v_add_f32 v30, v30, v31
    s_mov_b32 s72, 2
    v_cmp_nge_f32 vcc, s71, v30
    s_cbranch_vccnz L_slow0
L_back2:
    v_add_f32 v29, v29, v30
    s_waitcnt lgkmcnt(6)
    v_mfma_f32_32x32x16_bf16 v[128:143], v[224:227], v[160:163], v[192:207]
    ds_read_b128 v[252:255], v19 offset:32768
    v_exp_f32 v32, v144
    v_exp_f32 v33, v145
    s_waitcnt lgkmcnt(6)
    v_mfma_f32_32x32x16_bf16 v[128:143], v[228:231], v[164:167], v[128:143]
    ds_read_b64_tr_b16 v[224:225], v20 offset:16384
    ds_read_b64_tr_b16 v[226:227], v20 offset:18432
    v_exp_f32 v34, v146
    v_exp_f32 v35, v147
    s_waitcnt lgkmcnt(7)
    v_mfma_f32_32x32x16_bf16 v[128:143], v[232:235], v[168:171], v[128:143]
    ds_read_b64_tr_b16 v[228:229], v21 offset:16384
    ds_read_b64_tr_b16 v[230:231], v21 offset:18432
    v_cvt_pk_bf16_f32 v216, v32, v33
    v_exp_f32 v36, v148
    v_exp_f32 v37, v149
    s_waitcnt lgkmcnt(8)
    v_mfma_f32_32x32x16_bf16 v[128:143], v[236:239], v[172:175], v[128:143]
    ds_read_b64_tr_b16 v[232:233], v22 offset:16384
    ds_read_b64_tr_b16 v[234:235], v22 offset:18432
    v_add_f32 v30, v32, v34
    v_add_f32 v31, v33, v35
    s_waitcnt lgkmcnt(9)
    v_mfma_f32_32x32x16_bf16 v[128:143], v[240:243], v[176:179], v[128:143]
    ds_read_b64_tr_b16 v[236:237], v23 offset:16384
    ds_read_b64_tr_b16 v[238:239], v23 offset:18432
    v_cvt_pk_bf16_f32 v217, v34, v35
    v_exp_f32 v38, v150
    v_exp_f32 v39, v151
    s_waitcnt lgkmcnt(10)
    v_mfma_f32_32x32x16_bf16 v[128:143], v[244:247], v[180:183], v[128:143]
    ds_read_b64_tr_b16 v[240:241], v20 offset:20480
    ds_read_b64_tr_b16 v[242:243], v20 offset:22528
    v_add_f32 v30, v30, v36
    v_add_f32 v31, v31, v37
    s_waitcnt lgkmcnt(11)
    v_mfma_f32_32x32x16_bf16 v[128:143], v[248:251], v[184:187], v[128:143]
    ds_read_b64_tr_b16 v[244:245], v21 offset:20480
    ds_read_b64_tr_b16 v[246:247], v21 offset:22528
    v_cvt_pk_bf16_f32 v218, v36, v37
    v_exp_f32 v32, v152
    v_exp_f32 v33, v153
    s_waitcnt lgkmcnt(12)
    v_mfma_f32_32x32x16_bf16 v[128:143], v[252:255], v[188:191], v[128:143]
    ds_read_b64_tr_b16 v[248:249], v22 offset:20480
    ds_read_b64_tr_b16 v[250:251], v22 offset:22528
    v_add_f32 v30, v30, v38
    v_add_f32 v31, v31, v39
    s_waitcnt lgkmcnt(12)
    v_mfma_f32_32x32x16_bf16 v[64:79], v[224:227], v[208:211], v[64:79]
    ds_read_b64_tr_b16 v[252:253], v23 offset:20480
    ds_read_b64_tr_b16 v[254:255], v23 offset:22528
    v_cvt_pk_bf16_f32 v219, v38, v39
    v_exp_f32 v34, v154
    s_waitcnt lgkmcnt(12)
    v_mfma_f32_32x32x16_bf16 v[80:95], v[228:231], v[208:211], v[80:95]
    v_exp_f32 v35, v155
    v_add_f32 v30, v30, v32
    v_add_f32 v31, v31, v33
    s_waitcnt lgkmcnt(10)
    v_mfma_f32_32x32x16_bf16 v[96:111], v[232:235], v[208:211], v[96:111]
    v_cvt_pk_bf16_f32 v220, v32, v33
    v_exp_f32 v36, v156
    s_waitcnt lgkmcnt(8)
    v_mfma_f32_32x32x16_bf16 v[112:127], v[236:239], v[208:211], v[112:127]
    v_exp_f32 v37, v157
    v_add_f32 v30, v30, v34
    v_add_f32 v31, v31, v35
    s_waitcnt vmcnt(12) lgkmcnt(0)
    s_barrier
    ds_read_b128 v[224:227], v12 offset:40960
    ds_read_b128 v[228:231], v13 offset:40960
    ds_read_b128 v[232:235], v14 offset:40960
    v_mfma_f32_32x32x16_bf16 v[64:79], v[240:243], v[212:215], v[64:79]
    ds_read_b128 v[236:239], v15 offset:40960
    s_add_u32 m0, s70, 16384
    s_xor_b32 s75, s68, 49152
    buffer_load_dwordx4 v26, s[48:51], s75 offen offset:0 nt lds
    v_cvt_pk_bf16_f32 v221, v34, v35
    v_exp_f32 v38, v158
    v_mfma_f32_32x32x16_bf16 v[80:95], v[244:247], v[212:215], v[80:95]
    ds_read_b128 v[240:243], v16 offset:40960
    buffer_load_dwordx4 v26, s[48:51], s75 offen offset:1024 nt lds
    v_exp_f32 v39, v159
    v_add_f32 v30, v30, v36
    v_add_f32 v31, v31, v37
    v_mfma_f32_32x32x16_bf16 v[96:111], v[248:251], v[212:215], v[96:111]
    ds_read_b128 v[244:247], v17 offset:40960
    s_cmp_lg_u32 s10, 0
    s_cbranch_scc1 L_altk4
    s_add_u32 m0, s69, 32768
    s_xor_b32 s75, s68, 81920
    buffer_load_dwordx4 v24, s[44:47], s75 offen offset:0 nt lds
    buffer_load_dwordx4 v25, s[44:47], s75 offen offset:1024 nt lds
L_retk4:
    v_cvt_pk_bf16_f32 v222, v36, v37
    v_add_f32 v30, v30, v38
    v_mfma_f32_32x32x16_bf16 v[112:127], v[252:255], v[212:215], v[112:127]
    ds_read_b128 v[248:251], v18 offset:40960
    v_add_f32 v31, v31, v39
    v_cvt_pk_bf16_f32 v223, v38, v39
    v_add_f32 v30, v30, v31
    s_mov_b32 s72, 3
    v_cmp_nge_f32 vcc, s71, v30
    s_cbranch_vccnz L_slow1
L_back3:
    v_add_f32 v29, v29, v30
    s_waitcnt lgkmcnt(6)
    v_mfma_f32_32x32x16_bf16 v[144:159], v[224:227], v[160:163], v[192:207]
    ds_read_b128 v[252:255], v19 offset:40960
    v_exp_f32 v32, v128
    v_exp_f32 v33, v129
    s_waitcnt lgkmcnt(6)
    v_mfma_f32_32x32x16_bf16 v[144:159], v[228:231], v[164:167], v[144:159]
    ds_read_b64_tr_b16 v[224:225], v20 offset:24576
    ds_read_b64_tr_b16 v[226:227], v20 offset:26624
    v_exp_f32 v34, v130
    v_exp_f32 v35, v131
    s_waitcnt lgkmcnt(7)
    v_mfma_f32_32x32x16_bf16 v[144:159], v[232:235], v[168:171], v[144:159]
    ds_read_b64_tr_b16 v[228:229], v21 offset:24576
    ds_read_b64_tr_b16 v[230:231], v21 offset:26624
    v_cvt_pk_bf16_f32 v208, v32, v33
    v_exp_f32 v36, v132
    v_exp_f32 v37, v133
    s_waitcnt lgkmcnt(8)
    v_mfma_f32_32x32x16_bf16 v[144:159], v[236:239], v[172:175], v[144:159]
    ds_read_b64_tr_b16 v[232:233], v22 offset:24576
    ds_read_b64_tr_b16 v[234:235], v22 offset:26624
    v_add_f32 v30, v32, v34
    v_add_f32 v31, v33, v35
    s_waitcnt lgkmcnt(9)
    v_mfma_f32_32x32x16_bf16 v[144:159], v[240:243], v[176:179], v[144:159]
    ds_read_b64_tr_b16 v[236:237], v23 offset:24576
    ds_read_b64_tr_b16 v[238:239], v23 offset:26624
    v_cvt_pk_bf16_f32 v209, v34, v35
    v_exp_f32 v38, v134
    v_exp_f32 v39, v135
    s_waitcnt lgkmcnt(10)
    v_mfma_f32_32x32x16_bf16 v[144:159], v[244:247], v[180:183], v[144:159]
    ds_read_b64_tr_b16 v[240:241], v20 offset:28672
    ds_read_b64_tr_b16 v[242:243], v20 offset:30720
    v_add_f32 v30, v30, v36
    v_add_f32 v31, v31, v37
    s_waitcnt lgkmcnt(11)
    v_mfma_f32_32x32x16_bf16 v[144:159], v[248:251], v[184:187], v[144:159]
    ds_read_b64_tr_b16 v[244:245], v21 offset:28672
    ds_read_b64_tr_b16 v[246:247], v21 offset:30720
    v_cvt_pk_bf16_f32 v210, v36, v37
    v_exp_f32 v32, v136
    v_exp_f32 v33, v137
    s_waitcnt lgkmcnt(12)
    v_mfma_f32_32x32x16_bf16 v[144:159], v[252:255], v[188:191], v[144:159]
    ds_read_b64_tr_b16 v[248:249], v22 offset:28672
    ds_read_b64_tr_b16 v[250:251], v22 offset:30720
    v_add_f32 v30, v30, v38
    v_add_f32 v31, v31, v39
    s_waitcnt lgkmcnt(12)
    v_mfma_f32_32x32x16_bf16 v[64:79], v[224:227], v[216:219], v[64:79]
    ds_read_b64_tr_b16 v[252:253], v23 offset:28672
    ds_read_b64_tr_b16 v[254:255], v23 offset:30720
    v_cvt_pk_bf16_f32 v211, v38, v39
    v_exp_f32 v34, v138
    s_waitcnt lgkmcnt(12)
    v_mfma_f32_32x32x16_bf16 v[80:95], v[228:231], v[216:219], v[80:95]
    v_exp_f32 v35, v139
    v_add_f32 v30, v30, v32
    v_add_f32 v31, v31, v33
    s_waitcnt lgkmcnt(10)
    v_mfma_f32_32x32x16_bf16 v[96:111], v[232:235], v[216:219], v[96:111]
    v_cvt_pk_bf16_f32 v212, v32, v33
    v_exp_f32 v36, v140
    s_waitcnt lgkmcnt(8)
    v_mfma_f32_32x32x16_bf16 v[112:127], v[236:239], v[216:219], v[112:127]
    v_exp_f32 v37, v141
    v_add_f32 v30, v30, v34
    v_add_f32 v31, v31, v35
    s_cmp_eq_u32 s10, 0
    s_cbranch_scc1 L_bw5
    s_waitcnt vmcnt(6)
L_bw5:
    s_waitcnt vmcnt(10) lgkmcnt(0)
    s_barrier
    ds_read_b128 v[224:227], v12 offset:0
    ds_read_b128 v[228:231], v13 offset:0
    ds_read_b128 v[232:235], v14 offset:0
    v_mfma_f32_32x32x16_bf16 v[64:79], v[240:243], v[220:223], v[64:79]
    ds_read_b128 v[236:239], v15 offset:0
    s_add_u32 m0, s70, 24576
    s_xor_b32 s75, s68, 57344
    buffer_load_dwordx4 v26, s[48:51], s75 offen offset:0 nt lds
    v_cvt_pk_bf16_f32 v213, v34, v35
    v_exp_f32 v38, v142
    v_mfma_f32_32x32x16_bf16 v[80:95], v[244:247], v[220:223], v[80:95]
    ds_read_b128 v[240:243], v16 offset:0
    buffer_load_dwordx4 v26, s[48:51], s75 offen offset:1024 nt lds
    v_exp_f32 v39, v143
    v_add_f32 v30, v30, v36
    v_add_f32 v31, v31, v37
    v_mfma_f32_32x32x16_bf16 v[96:111], v[248:251], v[220:223], v[96:111]
    ds_read_b128 v[244:247], v17 offset:0
    s_cmp_lg_u32 s10, 0
    s_cbranch_scc1 L_altk5
    s_add_u32 m0, s69, 40960
    s_xor_b32 s75, s68, 90112
    buffer_load_dwordx4 v24, s[44:47], s75 offen offset:0 nt lds
    buffer_load_dwordx4 v25, s[44:47], s75 offen offset:1024 nt lds
L_retk5:
    v_cvt_pk_bf16_f32 v214, v36, v37
    v_add_f32 v30, v30, v38
    v_mfma_f32_32x32x16_bf16 v[112:127], v[252:255], v[220:223], v[112:127]
    ds_read_b128 v[248:251], v18 offset:0
    v_add_f32 v31, v31, v39
    v_cvt_pk_bf16_f32 v215, v38, v39
    v_add_f32 v30, v30, v31
    s_mov_b32 s72, 4
    v_cmp_nge_f32 vcc, s71, v30
    s_cbranch_vccnz L_slow0
L_back4:
    v_add_f32 v29, v29, v30
    s_waitcnt lgkmcnt(6)
    v_mfma_f32_32x32x16_bf16 v[128:143], v[224:227], v[160:163], v[192:207]
    ds_read_b128 v[252:255], v19 offset:0
    v_exp_f32 v32, v144
    v_exp_f32 v33, v145
    s_waitcnt lgkmcnt(6)
    v_mfma_f32_32x32x16_bf16 v[128:143], v[228:231], v[164:167], v[128:143]
    ds_read_b64_tr_b16 v[224:225], v20 offset:0
    ds_read_b64_tr_b16 v[226:227], v20 offset:2048
    v_exp_f32 v34, v146
    v_exp_f32 v35, v147
    s_waitcnt lgkmcnt(7)
    v_mfma_f32_32x32x16_bf16 v[128:143], v[232:235], v[168:171], v[128:143]
    ds_read_b64_tr_b16 v[228:229], v21 offset:0
    ds_read_b64_tr_b16 v[230:231], v21 offset:2048
    v_cvt_pk_bf16_f32 v216, v32, v33
    v_exp_f32 v36, v148
    v_exp_f32 v37, v149
    s_waitcnt lgkmcnt(8)
    v_mfma_f32_32x32x16_bf16 v[128:143], v[236:239], v[172:175], v[128:143]
    ds_read_b64_tr_b16 v[232:233], v22 offset:0
    ds_read_b64_tr_b16 v[234:235], v22 offset:2048
    v_add_f32 v30, v32, v34
    v_add_f32 v31, v33, v35
    s_waitcnt lgkmcnt(9)
    v_mfma_f32_32x32x16_bf16 v[128:143], v[240:243], v[176:179], v[128:143]
    ds_read_b64_tr_b16 v[236:237], v23 offset:0
    ds_read_b64_tr_b16 v[238:239], v23 offset:2048
    v_cvt_pk_bf16_f32 v217, v34, v35
    v_exp_f32 v38, v150
    v_exp_f32 v39, v151
    s_waitcnt lgkmcnt(10)
    v_mfma_f32_32x32x16_bf16 v[128:143], v[244:247], v[180:183], v[128:143]
    ds_read_b64_tr_b16 v[240:241], v20 offset:4096
    ds_read_b64_tr_b16 v[242:243], v20 offset:6144
    v_add_f32 v30, v30, v36
    v_add_f32 v31, v31, v37
    s_waitcnt lgkmcnt(11)
    v_mfma_f32_32x32x16_bf16 v[128:143], v[248:251], v[184:187], v[128:143]
    ds_read_b64_tr_b16 v[244:245], v21 offset:4096
    ds_read_b64_tr_b16 v[246:247], v21 offset:6144
    v_cvt_pk_bf16_f32 v218, v36, v37
    v_exp_f32 v32, v152
    v_exp_f32 v33, v153
    s_waitcnt lgkmcnt(12)
    v_mfma_f32_32x32x16_bf16 v[128:143], v[252:255], v[188:191], v[128:143]
    ds_read_b64_tr_b16 v[248:249], v22 offset:4096
    ds_read_b64_tr_b16 v[250:251], v22 offset:6144
    v_add_f32 v30, v30, v38
    v_add_f32 v31, v31, v39
    s_waitcnt lgkmcnt(12)
    v_mfma_f32_32x32x16_bf16 v[64:79], v[224:227], v[208:211], v[64:79]
    ds_read_b64_tr_b16 v[252:253], v23 offset:4096
    ds_read_b64_tr_b16 v[254:255], v23 offset:6144
    v_cvt_pk_bf16_f32 v219, v38, v39
    v_exp_f32 v34, v154
    s_waitcnt lgkmcnt(12)
    v_mfma_f32_32x32x16_bf16 v[80:95], v[228:231], v[208:211], v[80:95]
    v_exp_f32 v35, v155
    v_add_f32 v30, v30, v32
    v_add_f32 v31, v31, v33
    s_waitcnt lgkmcnt(10)
    v_mfma_f32_32x32x16_bf16 v[96:111], v[232:235], v[208:211], v[96:111]
    v_cvt_pk_bf16_f32 v220, v32, v33
    v_exp_f32 v36, v156
    s_waitcnt lgkmcnt(8)
    v_mfma_f32_32x32x16_bf16 v[112:127], v[236:239], v[208:211], v[112:127]
    v_exp_f32 v37, v157
    v_add_f32 v30, v30, v34
    v_add_f32 v31, v31, v35
    s_cmp_eq_u32 s10, 0
    s_cbranch_scc1 L_bw6
    s_waitcnt vmcnt(8)
L_bw6:
    s_waitcnt vmcnt(10) lgkmcnt(0)
    s_barrier
    ds_read_b128 v[224:227], v12 offset:8192
    ds_read_b128 v[228:231], v13 offset:8192
    ds_read_b128 v[232:235], v14 offset:8192
    v_mfma_f32_32x32x16_bf16 v[64:79], v[240:243], v[212:215], v[64:79]
    ds_read_b128 v[236:239], v15 offset:8192
    s_add_u32 m0, s70, 0
    s_xor_b32 s75, s68, 65536
    buffer_load_dwordx4 v26, s[48:51], s75 offen offset:0 nt lds
    v_cvt_pk_bf16_f32 v221, v34, v35
    v_exp_f32 v38, v158
    v_mfma_f32_32x32x16_bf16 v[80:95], v[244:247], v[212:215], v[80:95]
    ds_read_b128 v[240:243], v16 offset:8192
    buffer_load_dwordx4 v26, s[48:51], s75 offen offset:1024 nt lds
    v_exp_f32 v39, v159
    v_add_f32 v30, v30, v36
    v_add_f32 v31, v31, v37
    v_mfma_f32_32x32x16_bf16 v[96:111], v[248:251], v[212:215], v[96:111]
    ds_read_b128 v[244:247], v17 offset:8192
    s_cmp_lg_u32 s10, 0
    s_cbranch_scc1 L_altk6
    s_add_u32 m0, s69, 0
    s_xor_b32 s75, s68, 98304
    buffer_load_dwordx4 v24, s[44:47], s75 offen offset:0 nt lds
    buffer_load_dwordx4 v25, s[44:47], s75 offen offset:1024 nt lds
L_retk6:
    v_cvt_pk_bf16_f32 v222, v36, v37
    v_add_f32 v30, v30, v38
    v_mfma_f32_32x32x16_bf16 v[112:127], v[252:255], v[212:215], v[112:127]
    ds_read_b128 v[248:251], v18 offset:8192
    v_add_f32 v31, v31, v39
    v_cvt_pk_bf16_f32 v223, v38, v39
    v_add_f32 v30, v30, v31
    s_mov_b32 s72, 5
    v_cmp_nge_f32 vcc, s71, v30
    s_cbranch_vccnz L_slow1
L_back5:
    v_add_f32 v29, v29, v30
    s_waitcnt lgkmcnt(6)
    v_mfma_f32_32x32x16_bf16 v[144:159], v[224:227], v[160:163], v[192:207]
    ds_read_b128 v[252:255], v19 offset:8192
    v_exp_f32 v32, v128
    v_exp_f32 v33, v129
    s_waitcnt lgkmcnt(6)
    v_mfma_f32_32x32x16_bf16 v[144:159], v[228:231], v[164:167], v[144:159]
    ds_read_b64_tr_b16 v[224:225], v20 offset:8192
    ds_read_b64_tr_b16 v[226:227], v20 offset:10240
    v_exp_f32 v34, v130
    v_exp_f32 v35, v131
    s_waitcnt lgkmcnt(7)
    v_mfma_f32_32x32x16_bf16 v[144:159], v[232:235], v[168:171], v[144:159]
    ds_read_b64_tr_b16 v[228:229], v21 offset:8192
    ds_read_b64_tr_b16 v[230:231], v21 offset:10240
    v_cvt_pk_bf16_f32 v208, v32, v33
    v_exp_f32 v36, v132
    v_exp_f32 v37, v133
    s_waitcnt lgkmcnt(8)
    v_mfma_f32_32x32x16_bf16 v[144:159], v[236:239], v[172:175], v[144:159]
    ds_read_b64_tr_b16 v[232:233], v22 offset:8192
    ds_read_b64_tr_b16 v[234:235], v22 offset:10240
    v_add_f32 v30, v32, v34
    v_add_f32 v31, v33, v35
    s_waitcnt lgkmcnt(9)
    v_mfma_f32_32x32x16_bf16 v[144:159], v[240:243], v[176:179], v[144:159]
    ds_read_b64_tr_b16 v[236:237], v23 offset:8192
    ds_read_b64_tr_b16 v[238:239], v23 offset:10240
    v_cvt_pk_bf16_f32 v209, v34, v35
    v_exp_f32 v38, v134
    v_exp_f32 v39, v135
    s_waitcnt lgkmcnt(10)
    v_mfma_f32_32x32x16_bf16 v[144:159], v[244:247], v[180:183], v[144:159]
    ds_read_b64_tr_b16 v[240:241], v20 offset:12288
    ds_read_b64_tr_b16 v[242:243], v20 offset:14336
    v_add_f32 v30, v30, v36
    v_add_f32 v31, v31, v37
    s_waitcnt lgkmcnt(11)
    v_mfma_f32_32x32x16_bf16 v[144:159], v[248:251], v[184:187], v[144:159]
    ds_read_b64_tr_b16 v[244:245], v21 offset:12288
    ds_read_b64_tr_b16 v[246:247], v21 offset:14336
    v_cvt_pk_bf16_f32 v210, v36, v37
    v_exp_f32 v32, v136
    v_exp_f32 v33, v137
    s_waitcnt lgkmcnt(12)
    v_mfma_f32_32x32x16_bf16 v[144:159], v[252:255], v[188:191], v[144:159]
    ds_read_b64_tr_b16 v[248:249], v22 offset:12288
    ds_read_b64_tr_b16 v[250:251], v22 offset:14336
    v_add_f32 v30, v30, v38
    v_add_f32 v31, v31, v39
    s_waitcnt lgkmcnt(12)
    v_mfma_f32_32x32x16_bf16 v[64:79], v[224:227], v[216:219], v[64:79]
    ds_read_b64_tr_b16 v[252:253], v23 offset:12288
    ds_read_b64_tr_b16 v[254:255], v23 offset:14336
    v_cvt_pk_bf16_f32 v211, v38, v39
    v_exp_f32 v34, v138
    s_waitcnt lgkmcnt(12)
    v_mfma_f32_32x32x16_bf16 v[80:95], v[228:231], v[216:219], v[80:95]
    v_exp_f32 v35, v139
    v_add_f32 v30, v30, v32
    v_add_f32 v31, v31, v33
    s_waitcnt lgkmcnt(10)
    v_mfma_f32_32x32x16_bf16 v[96:111], v[232:235], v[216:219], v[96:111]
    v_cvt_pk_bf16_f32 v212, v32, v33
    v_exp_f32 v36, v140
    s_waitcnt lgkmcnt(8)
    v_mfma_f32_32x32x16_bf16 v[112:127], v[236:239], v[216:219], v[112:127]
    v_exp_f32 v37, v141
    v_add_f32 v30, v30, v34
    v_add_f32 v31, v31, v35
    s_cmp_eq_u32 s10, 0
    s_cbranch_scc1 L_bw7
    s_waitcnt vmcnt(8)
L_bw7:
    s_waitcnt vmcnt(10) lgkmcnt(0)
    s_barrier
    ds_read_b128 v[224:227], v12 offset:16384
    ds_read_b128 v[228:231], v13 offset:16384
    ds_read_b128 v[232:235], v14 offset:16384
    v_mfma_f32_32x32x16_bf16 v[64:79], v[240:243], v[220:223], v[64:79]
    ds_read_b128 v[236:239], v15 offset:16384
    s_add_u32 m0, s70, 8192
    s_xor_b32 s75, s68, 73728
    buffer_load_dwordx4 v26, s[48:51], s75 offen offset:0 nt lds
    v_cvt_pk_bf16_f32 v213, v34, v35
    v_exp_f32 v38, v142
    v_mfma_f32_32x32x16_bf16 v[80:95], v[244:247], v[220:223], v[80:95]
    ds_read_b128 v[240:243], v16 offset:16384
    buffer_load_dwordx4 v26, s[48:51], s75 offen offset:1024 nt lds
    v_exp_f32 v39, v143
    v_add_f32 v30, v30, v36
    v_add_f32 v31, v31, v37
    v_mfma_f32_32x32x16_bf16 v[96:111], v[248:251], v[220:223], v[96:111]
    ds_read_b128 v[244:247], v17 offset:16384
    s_cmp_lg_u32 s10, 0
    s_cbranch_scc1 L_altk7
    s_add_u32 m0, s69, 8192
    s_xor_b32 s75, s68, 106496
    buffer_load_dwordx4 v24, s[44:47], s75 offen offset:0 nt lds
    buffer_load_dwordx4 v25, s[44:47], s75 offen offset:1024 nt lds
L_retk7:
    v_cvt_pk_bf16_f32 v214, v36, v37
    v_add_f32 v30, v30, v38
    v_mfma_f32_32x32x16_bf16 v[112:127], v[252:255], v[220:223], v[112:127]
    ds_read_b128 v[248:251], v18 offset:16384
    v_add_f32 v31, v31, v39
    v_cvt_pk_bf16_f32 v215, v38, v39
    v_add_f32 v30, v30, v31
    s_mov_b32 s72, 6
    v_cmp_nge_f32 vcc, s71, v30
    s_cbranch_vccnz L_slow0
L_back6:
    v_add_f32 v29, v29, v30
    s_waitcnt lgkmcnt(6)
    v_mfma_f32_32x32x16_bf16 v[128:143], v[224:227], v[160:163], v[192:207]
    ds_read_b128 v[252:255], v19 offset:16384
    v_exp_f32 v32, v144
    v_exp_f32 v33, v145
    s_waitcnt lgkmcnt(6)
    v_mfma_f32_32x32x16_bf16 v[128:143], v[228:231], v[164:167], v[128:143]
    ds_read_b64_tr_b16 v[224:225], v20 offset:16384
    ds_read_b64_tr_b16 v[226:227], v20 offset:18432
    v_exp_f32 v34, v146
    v_exp_f32 v35, v147
    s_waitcnt lgkmcnt(7)
    v_mfma_f32_32x32x16_bf16 v[128:143], v[232:235], v[168:171], v[128:143]
    ds_read_b64_tr_b16 v[228:229], v21 offset:16384
    ds_read_b64_tr_b16 v[230:231], v21 offset:18432
    v_cvt_pk_bf16_f32 v216, v32, v33
    v_exp_f32 v36, v148
    v_exp_f32 v37, v149
    s_waitcnt lgkmcnt(8)
    v_mfma_f32_32x32x16_bf16 v[128:143], v[236:239], v[172:175], v[128:143]
    ds_read_b64_tr_b16 v[232:233], v22 offset:16384
    ds_read_b64_tr_b16 v[234:235], v22 offset:18432
    v_add_f32 v30, v32, v34
    v_add_f32 v31, v33, v35
    s_waitcnt lgkmcnt(9)
    v_mfma_f32_32x32x16_bf16 v[128:143], v[240:243], v[176:179], v[128:143]
    ds_read_b64_tr_b16 v[236:237], v23 offset:16384
    ds_read_b64_tr_b16 v[238:239], v23 offset:18432
    v_cvt_pk_bf16_f32 v217, v34, v35
    v_exp_f32 v38, v150
    v_exp_f32 v39, v151
    s_waitcnt lgkmcnt(10)
    v_mfma_f32_32x32x16_bf16 v[128:143], v[244:247], v[180:183], v[128:143]
    ds_read_b64_tr_b16 v[240:241], v20 offset:20480
    ds_read_b64_tr_b16 v[242:243], v20 offset:22528
    v_add_f32 v30, v30, v36
    v_add_f32 v31, v31, v37
    s_waitcnt lgkmcnt(11)
    v_mfma_f32_32x32x16_bf16 v[128:143], v[248:251], v[184:187], v[128:143]
    ds_read_b64_tr_b16 v[244:245], v21 offset:20480
    ds_read_b64_tr_b16 v[246:247], v21 offset:22528
    v_cvt_pk_bf16_f32 v218, v36, v37
    v_exp_f32 v32, v152
    v_exp_f32 v33, v153
    s_waitcnt lgkmcnt(12)
    v_mfma_f32_32x32x16_bf16 v[128:143], v[252:255], v[188:191], v[128:143]
    ds_read_b64_tr_b16 v[248:249], v22 offset:20480
    ds_read_b64_tr_b16 v[250:251], v22 offset:22528
    v_add_f32 v30, v30, v38
    v_add_f32 v31, v31, v39
    s_waitcnt lgkmcnt(12)
    v_mfma_f32_32x32x16_bf16 v[64:79], v[224:227], v[208:211], v[64:79]
    ds_read_b64_tr_b16 v[252:253], v23 offset:20480
    ds_read_b64_tr_b16 v[254:255], v23 offset:22528
    v_cvt_pk_bf16_f32 v219, v38, v39
    v_exp_f32 v34, v154
    s_waitcnt lgkmcnt(12)
    v_mfma_f32_32x32x16_bf16 v[80:95], v[228:231], v[208:211], v[80:95]
    v_exp_f32 v35, v155
    v_add_f32 v30, v30, v32
    v_add_f32 v31, v31, v33
    s_waitcnt lgkmcnt(10)
    v_mfma_f32_32x32x16_bf16 v[96:111], v[232:235], v[208:211], v[96:111]
    v_cvt_pk_bf16_f32 v220, v32, v33
    v_exp_f32 v36, v156
    s_waitcnt lgkmcnt(8)
    v_mfma_f32_32x32x16_bf16 v[112:127], v[236:239], v[208:211], v[112:127]
    v_exp_f32 v37, v157
    v_add_f32 v30, v30, v34
    v_add_f32 v31, v31, v35
    s_cmp_eq_u32 s10, 0
    s_cbranch_scc1 L_bw8
    s_waitcnt vmcnt(8)
L_bw8:
    s_waitcnt vmcnt(10) lgkmcnt(0)
    s_barrier
    ds_read_b128 v[224:227], v12 offset:24576
    ds_read_b128 v[228:231], v13 offset:24576
    ds_read_b128 v[232:235], v14 offset:24576
    v_mfma_f32_32x32x16_bf16 v[64:79], v[240:243], v[212:215], v[64:79]
    ds_read_b128 v[236:239], v15 offset:24576
    s_add_u32 m0, s70, 16384
    s_xor_b32 s75, s68, 81920
    buffer_load_dwordx4 v26, s[48:51], s75 offen offset:0 nt lds
    v_cvt_pk_bf16_f32 v221, v34, v35
    v_exp_f32 v38, v158
    v_mfma_f32_32x32x16_bf16 v[80:95], v[244:247], v[212:215], v[80:95]
    ds_read_b128 v[240:243], v16 offset:24576
    buffer_load_dwordx4 v26, s[48:51], s75 offen offset:1024 nt lds
    v_exp_f32 v39, v159
    v_add_f32 v30, v30, v36
    v_add_f32 v31, v31, v37
    v_mfma_f32_32x32x16_bf16 v[96:111], v[248:251], v[212:215], v[96:111]
    ds_read_b128 v[244:247], v17 offset:24576
    s_cmp_lg_u32 s10, 0
    s_cbranch_scc1 L_altk8
    s_add_u32 m0, s69, 16384
    s_xor_b32 s75, s68, 114688
    buffer_load_dwordx4 v24, s[44:47], s75 offen offset:0 nt lds
    buffer_load_dwordx4 v25, s[44:47], s75 offen offset:1024 nt lds
L_retk8:
    v_cvt_pk_bf16_f32 v222, v36, v37
    v_add_f32 v30, v30, v38
    v_mfma_f32_32x32x16_bf16 v[112:127], v[252:255], v[212:215], v[112:127]
    ds_read_b128 v[248:251], v18 offset:24576
    v_add_f32 v31, v31, v39
    v_cvt_pk_bf16_f32 v223, v38, v39
    v_add_f32 v30, v30, v31
    s_mov_b32 s72, 7
    v_cmp_nge_f32 vcc, s71, v30
    s_cbranch_vccnz L_slow1
L_back7:
    v_add_f32 v29, v29, v30
    s_waitcnt lgkmcnt(6)
    v_mfma_f32_32x32x16_bf16 v[144:159], v[224:227], v[160:163], v[192:207]
    ds_read_b128 v[252:255], v19 offset:24576
    v_exp_f32 v32, v128
    v_exp_f32 v33, v129
    s_waitcnt lgkmcnt(6)
    v_mfma_f32_32x32x16_bf16 v[144:159], v[228:231], v[164:167], v[144:159]
    ds_read_b64_tr_b16 v[224:225], v20 offset:24576
    ds_read_b64_tr_b16 v[226:227], v20 offset:26624
    v_exp_f32 v34, v130
    v_exp_f32 v35, v131
    s_waitcnt lgkmcnt(7)
    v_mfma_f32_32x32x16_bf16 v[144:159], v[232:235], v[168:171], v[144:159]
    ds_read_b64_tr_b16 v[228:229], v21 offset:24576
    ds_read_b64_tr_b16 v[230:231], v21 offset:26624
    v_cvt_pk_bf16_f32 v208, v32, v33
    v_exp_f32 v36, v132
    v_exp_f32 v37, v133
    s_waitcnt lgkmcnt(8)
    v_mfma_f32_32x32x16_bf16 v[144:159], v[236:239], v[172:175], v[144:159]
    ds_read_b64_tr_b16 v[232:233], v22 offset:24576
    ds_read_b64_tr_b16 v[234:235], v22 offset:26624
    v_add_f32 v30, v32, v34
    v_add_f32 v31, v33, v35
    s_waitcnt lgkmcnt(9)
    v_mfma_f32_32x32x16_bf16 v[144:159], v[240:243], v[176:179], v[144:159]
    ds_read_b64_tr_b16 v[236:237], v23 offset:24576
    ds_read_b64_tr_b16 v[238:239], v23 offset:26624
    v_cvt_pk_bf16_f32 v209, v34, v35
    v_exp_f32 v38, v134
    v_exp_f32 v39, v135
    s_waitcnt lgkmcnt(10)
    v_mfma_f32_32x32x16_bf16 v[144:159], v[244:247], v[180:183], v[144:159]
    ds_read_b64_tr_b16 v[240:241], v20 offset:28672
    ds_read_b64_tr_b16 v[242:243], v20 offset:30720
    v_add_f32 v30, v30, v36
    v_add_f32 v31, v31, v37
    s_waitcnt lgkmcnt(11)
    v_mfma_f32_32x32x16_bf16 v[144:159], v[248:251], v[184:187], v[144:159]
    ds_read_b64_tr_b16 v[244:245], v21 offset:28672
    ds_read_b64_tr_b16 v[246:247], v21 offset:30720
    v_cvt_pk_bf16_f32 v210, v36, v37
    v_exp_f32 v32, v136
    v_exp_f32 v33, v137
    s_waitcnt lgkmcnt(12)
    v_mfma_f32_32x32x16_bf16 v[144:159], v[252:255], v[188:191], v[144:159]
    ds_read_b64_tr_b16 v[248:249], v22 offset:28672
    ds_read_b64_tr_b16 v[250:251], v22 offset:30720
    v_add_f32 v30, v30, v38
    v_add_f32 v31, v31, v39
    s_waitcnt lgkmcnt(12)
    v_mfma_f32_32x32x16_bf16 v[64:79], v[224:227], v[216:219], v[64:79]
    ds_read_b64_tr_b16 v[252:253], v23 offset:28672
    ds_read_b64_tr_b16 v[254:255], v23 offset:30720
    v_cvt_pk_bf16_f32 v211, v38, v39
    v_exp_f32 v34, v138
    s_waitcnt lgkmcnt(12)
    v_mfma_f32_32x32x16_bf16 v[80:95], v[228:231], v[216:219], v[80:95]
    v_exp_f32 v35, v139
    v_add_f32 v30, v30, v32
    v_add_f32 v31, v31, v33
    s_waitcnt lgkmcnt(10)
    v_mfma_f32_32x32x16_bf16 v[96:111], v[232:235], v[216:219], v[96:111]
    v_cvt_pk_bf16_f32 v212, v32, v33
    v_exp_f32 v36, v140
    s_waitcnt lgkmcnt(8)
    v_mfma_f32_32x32x16_bf16 v[112:127], v[236:239], v[216:219], v[112:127]
    v_exp_f32 v37, v141
    v_add_f32 v30, v30, v34
    v_add_f32 v31, v31, v35
    s_cmp_eq_u32 s10, 0
    s_cbranch_scc1 L_bw9
    s_waitcnt vmcnt(8)
L_bw9:
    s_waitcnt vmcnt(10) lgkmcnt(0)
    s_barrier
    ds_read_b128 v[224:227], v12 offset:32768
    ds_read_b128 v[228:231], v13 offset:32768
    ds_read_b128 v[232:235], v14 offset:32768
    v_mfma_f32_32x32x16_bf16 v[64:79], v[240:243], v[220:223], v[64:79]
    ds_read_b128 v[236:239], v15 offset:32768
    s_add_u32 m0, s70, 24576
    s_xor_b32 s75, s68, 90112
    buffer_load_dwordx4 v26, s[48:51], s75 offen offset:0 nt lds
    v_cvt_pk_bf16_f32 v213, v34, v35
    v_exp_f32 v38, v142
    v_mfma_f32_32x32x16_bf16 v[80:95], v[244:247], v[220:223], v[80:95]
    ds_read_b128 v[240:243], v16 offset:32768
    buffer_load_dwordx4 v26, s[48:51], s75 offen offset:1024 nt lds
    v_exp_f32 v39, v143
    v_add_f32 v30, v30, v36
    v_add_f32 v31, v31, v37
    v_mfma_f32_32x32x16_bf16 v[96:111], v[248:251], v[220:223], v[96:111]
    ds_read_b128 v[244:247], v17 offset:32768
    s_cmp_lg_u32 s10, 0
    s_cbranch_scc1 L_altk9
    s_add_u32 m0, s69, 24576
    s_xor_b32 s75, s68, 122880
    buffer_load_dwordx4 v24, s[44:47], s75 offen offset:0 nt lds
    buffer_load_dwordx4 v25, s[44:47], s75 offen offset:1024 nt lds
L_retk9:
    v_cvt_pk_bf16_f32 v214, v36, v37
    v_add_f32 v30, v30, v38
    v_mfma_f32_32x32x16_bf16 v[112:127], v[252:255], v[220:223], v[112:127]
    ds_read_b128 v[248:251], v18 offset:32768
    v_add_f32 v31, v31, v39
    v_cvt_pk_bf16_f32 v215, v38, v39
    v_add_f32 v30, v30, v31
    s_mov_b32 s72, 8
    v_cmp_nge_f32 vcc, s71, v30
    s_cbranch_vccnz L_slow0
L_back8:
    v_add_f32 v29, v29, v30
    s_waitcnt lgkmcnt(6)
    v_mfma_f32_32x32x16_bf16 v[128:143], v[224:227], v[160:163], v[192:207]
    ds_read_b128 v[252:255], v19 offset:32768
    v_exp_f32 v32, v144
    v_exp_f32 v33, v145
    s_waitcnt lgkmcnt(6)
    v_mfma_f32_32x32x16_bf16 v[128:143], v[228:231], v[164:167], v[128:143]
    ds_read_b64_tr_b16 v[224:225], v20 offset:0
    ds_read_b64_tr_b16 v[226:227], v20 offset:2048
    v_exp_f32 v34, v146
    v_exp_f32 v35, v147
    s_waitcnt lgkmcnt(7)
    v_mfma_f32_32x32x16_bf16 v[128:143], v[232:235], v[168:171], v[128:143]
    ds_read_b64_tr_b16 v[228:229], v21 offset:0
    ds_read_b64_tr_b16 v[230:231], v21 offset:2048
    v_cvt_pk_bf16_f32 v216, v32, v33
    v_exp_f32 v36, v148
    v_exp_f32 v37, v149
    s_waitcnt lgkmcnt(8)
    v_mfma_f32_32x32x16_bf16 v[128:143], v[236:239], v[172:175], v[128:143]
    ds_read_b64_tr_b16 v[232:233], v22 offset:0
    ds_read_b64_tr_b16 v[234:235], v22 offset:2048
    v_add_f32 v30, v32, v34
    v_add_f32 v31, v33, v35
    s_waitcnt lgkmcnt(9)
    v_mfma_f32_32x32x16_bf16 v[128:143], v[240:243], v[176:179], v[128:143]
    ds_read_b64_tr_b16 v[236:237], v23 offset:0
    ds_read_b64_tr_b16 v[238:239], v23 offset:2048
    v_cvt_pk_bf16_f32 v217, v34, v35
    v_exp_f32 v38, v150
    v_exp_f32 v39, v151
    s_waitcnt lgkmcnt(10)
    v_mfma_f32_32x32x16_bf16 v[128:143], v[244:247], v[180:183], v[128:143]
    ds_read_b64_tr_b16 v[240:241], v20 offset:4096
    ds_read_b64_tr_b16 v[242:243], v20 offset:6144
    v_add_f32 v30, v30, v36
    v_add_f32 v31, v31, v37
    s_waitcnt lgkmcnt(11)
    v_mfma_f32_32x32x16_bf16 v[128:143], v[248:251], v[184:187], v[128:143]
    ds_read_b64_tr_b16 v[244:245], v21 offset:4096
    ds_read_b64_tr_b16 v[246:247], v21 offset:6144
    v_cvt_pk_bf16_f32 v218, v36, v37
    v_exp_f32 v32, v152
    v_exp_f32 v33, v153
    s_waitcnt lgkmcnt(12)
    v_mfma_f32_32x32x16_bf16 v[128:143], v[252:255], v[188:191], v[128:143]
    ds_read_b64_tr_b16 v[248:249], v22 offset:4096
    ds_read_b64_tr_b16 v[250:251], v22 offset:6144
    v_add_f32 v30, v30, v38
    v_add_f32 v31, v31, v39
    s_waitcnt lgkmcnt(12)
    v_mfma_f32_32x32x16_bf16 v[64:79], v[224:227], v[208:211], v[64:79]
    ds_read_b64_tr_b16 v[252:253], v23 offset:4096
    ds_read_b64_tr_b16 v[254:255], v23 offset:6144
    v_cvt_pk_bf16_f32 v219, v38, v39
    v_exp_f32 v34, v154
    s_waitcnt lgkmcnt(12)
    v_mfma_f32_32x32x16_bf16 v[80:95], v[228:231], v[208:211], v[80:95]
    v_exp_f32 v35, v155
    v_add_f32 v30, v30, v32
    v_add_f32 v31, v31, v33
    s_waitcnt lgkmcnt(10)
    v_mfma_f32_32x32x16_bf16 v[96:111], v[232:235], v[208:211], v[96:111]
    v_cvt_pk_bf16_f32 v220, v32, v33
    v_exp_f32 v36, v156
    s_waitcnt lgkmcnt(8)
    v_mfma_f32_32x32x16_bf16 v[112:127], v[236:239], v[208:211], v[112:127]
    v_exp_f32 v37, v157
    v_add_f32 v30, v30, v34
    v_add_f32 v31, v31, v35
    s_cmp_eq_u32 s10, 0
    s_cbranch_scc1 L_bw10
    s_waitcnt vmcnt(8)
L_bw10:
    s_waitcnt vmcnt(10) lgkmcnt(0)
    s_barrier
    ds_read_b128 v[224:227], v12 offset:40960
    ds_read_b128 v[228:231], v13 offset:40960
    ds_read_b128 v[232:235], v14 offset:40960
    v_mfma_f32_32x32x16_bf16 v[64:79], v[240:243], v[212:215], v[64:79]
    ds_read_b128 v[236:239], v15 offset:40960
    s_add_u32 m0, s70, 0
    s_xor_b32 s75, s68, 98304
    buffer_load_dwordx4 v26, s[48:51], s75 offen offset:0 nt lds
    v_cvt_pk_bf16_f32 v221, v34, v35
    v_exp_f32 v38, v158
    v_mfma_f32_32x32x16_bf16 v[80:95], v[244:247], v[212:215], v[80:95]
    ds_read_b128 v[240:243], v16 offset:40960
    buffer_load_dwordx4 v26, s[48:51], s75 offen offset:1024 nt lds
    v_exp_f32 v39, v159
    v_add_f32 v30, v30, v36
    v_add_f32 v31, v31, v37
    v_mfma_f32_32x32x16_bf16 v[96:111], v[248:251], v[212:215], v[96:111]
    ds_read_b128 v[244:247], v17 offset:40960
    s_cmp_eq_u32 s10, 0
    s_cbranch_scc1 L_retk10
    s_add_u32 m0, s69, 16384
    s_xor_b32 s75, s68, 114688
    buffer_load_dwordx4 v24, s[44:47], s75 offen offset:0 nt lds
    buffer_load_dwordx4 v25, s[44:47], s75 offen offset:1024 nt lds
L_retk10:
    v_cvt_pk_bf16_f32 v222, v36, v37
    v_add_f32 v30, v30, v38
    v_mfma_f32_32x32x16_bf16 v[112:127], v[252:255], v[212:215], v[112:127]
    ds_read_b128 v[248:251], v18 offset:40960
    v_add_f32 v31, v31, v39
    v_cvt_pk_bf16_f32 v223, v38, v39
    v_add_f32 v30, v30, v31
    s_mov_b32 s72, 9
    v_cmp_nge_f32 vcc, s71, v30
    s_cbranch_vccnz L_slow1
L_back9:
    v_add_f32 v29, v29, v30
    s_waitcnt lgkmcnt(6)
    v_mfma_f32_32x32x16_bf16 v[144:159], v[224:227], v[160:163], v[192:207]
    ds_read_b128 v[252:255], v19 offset:40960
    v_exp_f32 v32, v128
    v_exp_f32 v33, v129
    s_waitcnt lgkmcnt(6)
    v_mfma_f32_32x32x16_bf16 v[144:159], v[228:231], v[164:167], v[144:159]
    ds_read_b64_tr_b16 v[224:225], v20 offset:8192
    ds_read_b64_tr_b16 v[226:227], v20 offset:10240
    v_exp_f32 v34, v130
    v_exp_f32 v35, v131
    s_waitcnt lgkmcnt(7)
    v_mfma_f32_32x32x16_bf16 v[144:159], v[232:235], v[168:171], v[144:159]
    ds_read_b64_tr_b16 v[228:229], v21 offset:8192
    ds_read_b64_tr_b16 v[230:231], v21 offset:10240
    v_cvt_pk_bf16_f32 v208, v32, v33
    v_exp_f32 v36, v132
    v_exp_f32 v37, v133
    s_waitcnt lgkmcnt(8)
    v_mfma_f32_32x32x16_bf16 v[144:159], v[236:239], v[172:175], v[144:159]
    ds_read_b64_tr_b16 v[232:233], v22 offset:8192
    ds_read_b64_tr_b16 v[234:235], v22 offset:10240
    v_add_f32 v30, v32, v34
    v_add_f32 v31, v33, v35
    s_waitcnt lgkmcnt(9)
    v_mfma_f32_32x32x16_bf16 v[144:159], v[240:243], v[176:179], v[144:159]
    ds_read_b64_tr_b16 v[236:237], v23 offset:8192
    ds_read_b64_tr_b16 v[238:239], v23 offset:10240
    v_cvt_pk_bf16_f32 v209, v34, v35
    v_exp_f32 v38, v134
    v_exp_f32 v39, v135
    s_waitcnt lgkmcnt(10)
    v_mfma_f32_32x32x16_bf16 v[144:159], v[244:247], v[180:183], v[144:159]
    ds_read_b64_tr_b16 v[240:241], v20 offset:12288
    ds_read_b64_tr_b16 v[242:243], v20 offset:14336
    v_add_f32 v30, v30, v36
    v_add_f32 v31, v31, v37
    s_waitcnt lgkmcnt(11)
    v_mfma_f32_32x32x16_bf16 v[144:159], v[248:251], v[184:187], v[144:159]
    ds_read_b64_tr_b16 v[244:245], v21 offset:12288
    ds_read_b64_tr_b16 v[246:247], v21 offset:14336
    v_cvt_pk_bf16_f32 v210, v36, v37
    v_exp_f32 v32, v136
    v_exp_f32 v33, v137
    s_waitcnt lgkmcnt(12)
    v_mfma_f32_32x32x16_bf16 v[144:159], v[252:255], v[188:191], v[144:159]
    ds_read_b64_tr_b16 v[248:249], v22 offset:12288
    ds_read_b64_tr_b16 v[250:251], v22 offset:14336
    v_add_f32 v30, v30, v38
    v_add_f32 v31, v31, v39
    s_waitcnt lgkmcnt(12)
    v_mfma_f32_32x32x16_bf16 v[64:79], v[224:227], v[216:219], v[64:79]
    ds_read_b64_tr_b16 v[252:253], v23 offset:12288
    ds_read_b64_tr_b16 v[254:255], v23 offset:14336
    v_cvt_pk_bf16_f32 v211, v38, v39
    v_exp_f32 v34, v138
    s_waitcnt lgkmcnt(12)
    v_mfma_f32_32x32x16_bf16 v[80:95], v[228:231], v[216:219], v[80:95]
    v_exp_f32 v35, v139
    v_add_f32 v30, v30, v32
    v_add_f32 v31, v31, v33
    s_waitcnt lgkmcnt(10)
    v_mfma_f32_32x32x16_bf16 v[96:111], v[232:235], v[216:219], v[96:111]
    v_cvt_pk_bf16_f32 v212, v32, v33
    v_exp_f32 v36, v140
    s_waitcnt lgkmcnt(8)
    v_mfma_f32_32x32x16_bf16 v[112:127], v[236:239], v[216:219], v[112:127]
    v_exp_f32 v37, v141
    v_add_f32 v30, v30, v34
    v_add_f32 v31, v31, v35
    s_waitcnt vmcnt(8) lgkmcnt(0)
    s_barrier
    ds_read_b128 v[224:227], v12 offset:0
    ds_read_b128 v[228:231], v13 offset:0
    ds_read_b128 v[232:235], v14 offset:0
    v_mfma_f32_32x32x16_bf16 v[64:79], v[240:243], v[220:223], v[64:79]
    ds_read_b128 v[236:239], v15 offset:0
    s_add_u32 m0, s70, 8192
    s_xor_b32 s75, s68, 106496
    buffer_load_dwordx4 v26, s[48:51], s75 offen offset:0 nt lds
    v_cvt_pk_bf16_f32 v213, v34, v35
    v_exp_f32 v38, v142
    v_mfma_f32_32x32x16_bf16 v[80:95], v[244:247], v[220:223], v[80:95]
    ds_read_b128 v[240:243], v16 offset:0
    buffer_load_dwordx4 v26, s[48:51], s75 offen offset:1024 nt lds
    v_exp_f32 v39, v143
    v_add_f32 v30, v30, v36
    v_add_f32 v31, v31, v37
    v_mfma_f32_32x32x16_bf16 v[96:111], v[248:251], v[220:223], v[96:111]
    ds_read_b128 v[244:247], v17 offset:0
    s_cmp_eq_u32 s10, 0
    s_cbranch_scc1 L_retk11
    s_add_u32 m0, s69, 24576
    s_xor_b32 s75, s68, 122880
    buffer_load_dwordx4 v24, s[44:47], s75 offen offset:0 nt lds
    buffer_load_dwordx4 v25, s[44:47], s75 offen offset:1024 nt lds
L_retk11:
    v_cvt_pk_bf16_f32 v214, v36, v37
    v_add_f32 v30, v30, v38
    v_mfma_f32_32x32x16_bf16 v[112:127], v[252:255], v[220:223], v[112:127]
    ds_read_b128 v[248:251], v18 offset:0
    v_add_f32 v31, v31, v39
    v_cvt_pk_bf16_f32 v215, v38, v39
    v_add_f32 v30, v30, v31
    s_mov_b32 s72, 10
    v_cmp_nge_f32 vcc, s71, v30
    s_cbranch_vccnz L_slow0
L_back10:
    v_add_f32 v29, v29, v30
    s_waitcnt lgkmcnt(6)
    v_mfma_f32_32x32x16_bf16 v[128:143], v[224:227], v[160:163], v[192:207]
    ds_read_b128 v[252:255], v19 offset:0
    v_exp_f32 v32, v144
    v_exp_f32 v33, v145
    s_waitcnt lgkmcnt(6)
    v_mfma_f32_32x32x16_bf16 v[128:143], v[228:231], v[164:167], v[128:143]
    ds_read_b64_tr_b16 v[224:225], v20 offset:16384
    ds_read_b64_tr_b16 v[226:227], v20 offset:18432
    v_exp_f32 v34, v146
    v_exp_f32 v35, v147
    s_waitcnt lgkmcnt(7)
    v_mfma_f32_32x32x16_bf16 v[128:143], v[232:235], v[168:171], v[128:143]
    ds_read_b64_tr_b16 v[228:229], v21 offset:16384
    ds_read_b64_tr_b16 v[230:231], v21 offset:18432
    v_cvt_pk_bf16_f32 v216, v32, v33
    v_exp_f32 v36, v148
    v_exp_f32 v37, v149
    s_waitcnt lgkmcnt(8)
    v_mfma_f32_32x32x16_bf16 v[128:143], v[236:239], v[172:175], v[128:143]
    ds_read_b64_tr_b16 v[232:233], v22 offset:16384
    ds_read_b64_tr_b16 v[234:235], v22 offset:18432
    v_add_f32 v30, v32, v34
    v_add_f32 v31, v33, v35
    s_waitcnt lgkmcnt(9)
    v_mfma_f32_32x32x16_bf16 v[128:143], v[240:243], v[176:179], v[128:143]
    ds_read_b64_tr_b16 v[236:237], v23 offset:16384
    ds_read_b64_tr_b16 v[238:239], v23 offset:18432
    v_cvt_pk_bf16_f32 v217, v34, v35
    v_exp_f32 v38, v150
    v_exp_f32 v39, v151
    s_waitcnt lgkmcnt(10)
    v_mfma_f32_32x32x16_bf16 v[128:143], v[244:247], v[180:183], v[128:143]
    ds_read_b64_tr_b16 v[240:241], v20 offset:20480
    ds_read_b64_tr_b16 v[242:243], v20 offset:22528
    v_add_f32 v30, v30, v36
    v_add_f32 v31, v31, v37
    s_waitcnt lgkmcnt(11)
    v_mfma_f32_32x32x16_bf16 v[128:143], v[248:251], v[184:187], v[128:143]
    ds_read_b64_tr_b16 v[244:245], v21 offset:20480
    ds_read_b64_tr_b16 v[246:247], v21 offset:22528
    v_cvt_pk_bf16_f32 v218, v36, v37
    v_exp_f32 v32, v152
    v_exp_f32 v33, v153
    s_waitcnt lgkmcnt(12)
    v_mfma_f32_32x32x16_bf16 v[128:143], v[252:255], v[188:191], v[128:143]
    ds_read_b64_tr_b16 v[248:249], v22 offset:20480
    ds_read_b64_tr_b16 v[250:251], v22 offset:22528
    v_add_f32 v30, v30, v38
    v_add_f32 v31, v31, v39
    s_waitcnt lgkmcnt(12)
    v_mfma_f32_32x32x16_bf16 v[64:79], v[224:227], v[208:211], v[64:79]
    ds_read_b64_tr_b16 v[252:253], v23 offset:20480
    ds_read_b64_tr_b16 v[254:255], v23 offset:22528
    v_cvt_pk_bf16_f32 v219, v38, v39
    v_exp_f32 v34, v154
    s_waitcnt lgkmcnt(12)
    v_mfma_f32_32x32x16_bf16 v[80:95], v[228:231], v[208:211], v[80:95]
    v_exp_f32 v35, v155
    v_add_f32 v30, v30, v32
    v_add_f32 v31, v31, v33
    s_waitcnt lgkmcnt(10)
    v_mfma_f32_32x32x16_bf16 v[96:111], v[232:235], v[208:211], v[96:111]
    v_cvt_pk_bf16_f32 v220, v32, v33
    v_exp_f32 v36, v156
    s_waitcnt lgkmcnt(8)
    v_mfma_f32_32x32x16_bf16 v[112:127], v[236:239], v[208:211], v[112:127]
    v_exp_f32 v37, v157
    v_add_f32 v30, v30, v34
    v_add_f32 v31, v31, v35
    s_cmp_lg_u32 s10, 0
    s_cbranch_scc1 L_bw12
    s_waitcnt vmcnt(6)
L_bw12:
    s_waitcnt vmcnt(8) lgkmcnt(0)
    s_barrier
    ds_read_b128 v[224:227], v12 offset:8192
    ds_read_b128 v[228:231], v13 offset:8192
    ds_read_b128 v[232:235], v14 offset:8192
    v_mfma_f32_32x32x16_bf16 v[64:79], v[240:243], v[212:215], v[64:79]
    ds_read_b128 v[236:239], v15 offset:8192
    s_add_u32 m0, s70, 16384
    s_xor_b32 s75, s68, 114688
    buffer_load_dwordx4 v26, s[48:51], s75 offen offset:0 nt lds
    v_cvt_pk_bf16_f32 v221, v34, v35
    v_exp_f32 v38, v158
    v_mfma_f32_32x32x16_bf16 v[80:95], v[244:247], v[212:215], v[80:95]
    ds_read_b128 v[240:243], v16 offset:8192
    buffer_load_dwordx4 v26, s[48:51], s75 offen offset:1024 nt lds
    v_exp_f32 v39, v159
    v_add_f32 v30, v30, v36
    v_add_f32 v31, v31, v37
    v_mfma_f32_32x32x16_bf16 v[96:111], v[248:251], v[212:215], v[96:111]
    ds_read_b128 v[244:247], v17 offset:8192
    v_cvt_pk_bf16_f32 v222, v36, v37
    v_add_f32 v30, v30, v38
    v_mfma_f32_32x32x16_bf16 v[112:127], v[252:255], v[212:215], v[112:127]
    ds_read_b128 v[248:251], v18 offset:8192
    v_add_f32 v31, v31, v39
    v_cvt_pk_bf16_f32 v223, v38, v39
    v_add_f32 v30, v30, v31
    s_mov_b32 s72, 11
    v_cmp_nge_f32 vcc, s71, v30
    s_cbranch_vccnz L_slow1
L_back11:
    v_add_f32 v29, v29, v30
    s_waitcnt lgkmcnt(6)
    v_mfma_f32_32x32x16_bf16 v[144:159], v[224:227], v[160:163], v[192:207]
    ds_read_b128 v[252:255], v19 offset:8192
    v_exp_f32 v32, v128
    v_exp_f32 v33, v129
    s_waitcnt lgkmcnt(6)
    v_mfma_f32_32x32x16_bf16 v[144:159], v[228:231], v[164:167], v[144:159]
    ds_read_b64_tr_b16 v[224:225], v20 offset:24576
    ds_read_b64_tr_b16 v[226:227], v20 offset:26624
    v_exp_f32 v34, v130
    v_exp_f32 v35, v131
    s_waitcnt lgkmcnt(7)
    v_mfma_f32_32x32x16_bf16 v[144:159], v[232:235], v[168:171], v[144:159]
    ds_read_b64_tr_b16 v[228:229], v21 offset:24576
    ds_read_b64_tr_b16 v[230:231], v21 offset:26624
    v_cvt_pk_bf16_f32 v208, v32, v33
    v_exp_f32 v36, v132
    v_exp_f32 v37, v133
    s_waitcnt lgkmcnt(8)
    v_mfma_f32_32x32x16_bf16 v[144:159], v[236:239], v[172:175], v[144:159]
    ds_read_b64_tr_b16 v[232:233], v22 offset:24576
    ds_read_b64_tr_b16 v[234:235], v22 offset:26624
    v_add_f32 v30, v32, v34
    v_add_f32 v31, v33, v35
    s_waitcnt lgkmcnt(9)
    v_mfma_f32_32x32x16_bf16 v[144:159], v[240:243], v[176:179], v[144:159]
    ds_read_b64_tr_b16 v[236:237], v23 offset:24576
    ds_read_b64_tr_b16 v[238:239], v23 offset:26624
    v_cvt_pk_bf16_f32 v209, v34, v35
    v_exp_f32 v38, v134
    v_exp_f32 v39, v135
    s_waitcnt lgkmcnt(10)
    v_mfma_f32_32x32x16_bf16 v[144:159], v[244:247], v[180:183], v[144:159]
    ds_read_b64_tr_b16 v[240:241], v20 offset:28672
    ds_read_b64_tr_b16 v[242:243], v20 offset:30720
    v_add_f32 v30, v30, v36
    v_add_f32 v31, v31, v37
    s_waitcnt lgkmcnt(11)
    v_mfma_f32_32x32x16_bf16 v[144:159], v[248:251], v[184:187], v[144:159]
    ds_read_b64_tr_b16 v[244:245], v21 offset:28672
    ds_read_b64_tr_b16 v[246:247], v21 offset:30720
    v_cvt_pk_bf16_f32 v210, v36, v37
    v_exp_f32 v32, v136
    v_exp_f32 v33, v137
    s_waitcnt lgkmcnt(12)
    v_mfma_f32_32x32x16_bf16 v[144:159], v[252:255], v[188:191], v[144:159]
    ds_read_b64_tr_b16 v[248:249], v22 offset:28672
    ds_read_b64_tr_b16 v[250:251], v22 offset:30720
    v_add_f32 v30, v30, v38
    v_add_f32 v31, v31, v39
    s_waitcnt lgkmcnt(12)
    v_mfma_f32_32x32x16_bf16 v[64:79], v[224:227], v[216:219], v[64:79]
    ds_read_b64_tr_b16 v[252:253], v23 offset:28672
    ds_read_b64_tr_b16 v[254:255], v23 offset:30720
    v_cvt_pk_bf16_f32 v211, v38, v39
    v_exp_f32 v34, v138
    s_waitcnt lgkmcnt(12)
    v_mfma_f32_32x32x16_bf16 v[80:95], v[228:231], v[216:219], v[80:95]
    v_exp_f32 v35, v139
    v_add_f32 v30, v30, v32
    v_add_f32 v31, v31, v33
    s_waitcnt lgkmcnt(10)
    v_mfma_f32_32x32x16_bf16 v[96:111], v[232:235], v[216:219], v[96:111]
    v_cvt_pk_bf16_f32 v212, v32, v33
    v_exp_f32 v36, v140
    s_waitcnt lgkmcnt(8)
    v_mfma_f32_32x32x16_bf16 v[112:127], v[236:239], v[216:219], v[112:127]
    v_exp_f32 v37, v141
    v_add_f32 v30, v30, v34
    v_add_f32 v31, v31, v35
    s_cmp_lg_u32 s10, 0
    s_cbranch_scc1 L_bw13
    s_waitcnt vmcnt(4)
L_bw13:
    s_waitcnt vmcnt(6) lgkmcnt(0)
    s_barrier
    ds_read_b128 v[224:227], v12 offset:16384
    ds_read_b128 v[228:231], v13 offset:16384
    ds_read_b128 v[232:235], v14 offset:16384
    v_mfma_f32_32x32x16_bf16 v[64:79], v[240:243], v[220:223], v[64:79]
    ds_read_b128 v[236:239], v15 offset:16384
    s_add_u32 m0, s70, 24576
    s_xor_b32 s75, s68, 122880
    buffer_load_dwordx4 v26, s[48:51], s75 offen offset:0 nt lds
    v_cvt_pk_bf16_f32 v213, v34, v35
    v_exp_f32 v38, v142
    v_mfma_f32_32x32x16_bf16 v[80:95], v[244:247], v[220:223], v[80:95]
    ds_read_b128 v[240:243], v16 offset:16384
    buffer_load_dwordx4 v26, s[48:51], s75 offen offset:1024 nt lds
    v_exp_f32 v39, v143
    v_add_f32 v30, v30, v36
    v_add_f32 v31, v31, v37
    v_mfma_f32_32x32x16_bf16 v[96:111], v[248:251], v[220:223], v[96:111]
    ds_read_b128 v[244:247], v17 offset:16384
    s_add_u32 s14, s9, 0
    s_and_b32 s14, s14, 7
    s_add_u32 s15, s74, 0
    s_and_b32 s15, s15, 24
    s_or_b32 s14, s14, s15
    s_lshl_b32 s14, s14, 14
    s_add_u32 s75, s14, s73
    s_add_u32 m0, s69, 32768
    s_nop 0
    buffer_load_dwordx4 v27, s[56:59], s75 offen offset:0 lds
    v_cvt_pk_bf16_f32 v214, v36, v37
    v_add_f32 v30, v30, v38
    v_mfma_f32_32x32x16_bf16 v[112:127], v[252:255], v[220:223], v[112:127]
    ds_read_b128 v[248:251], v18 offset:16384
    buffer_load_dwordx4 v28, s[56:59], s75 offen offset:1024 lds
    v_add_f32 v31, v31, v39
    v_cvt_pk_bf16_f32 v215, v38, v39
    v_add_f32 v30, v30, v31
    s_mov_b32 s72, 12
    v_cmp_nge_f32 vcc, s71, v30
    s_cbranch_vccnz L_slow0
L_back12:
    v_add_f32 v29, v29, v30
    s_waitcnt lgkmcnt(6)
    v_mfma_f32_32x32x16_bf16 v[128:143], v[224:227], v[160:163], v[192:207]
    ds_read_b128 v[252:255], v19 offset:16384
    v_exp_f32 v32, v144
    v_exp_f32 v33, v145
    s_waitcnt lgkmcnt(6)
    v_mfma_f32_32x32x16_bf16 v[128:143], v[228:231], v[164:167], v[128:143]
    ds_read_b64_tr_b16 v[224:225], v20 offset:0
    ds_read_b64_tr_b16 v[226:227], v20 offset:2048
    v_exp_f32 v34, v146
    v_exp_f32 v35, v147
    s_waitcnt lgkmcnt(7)
    v_mfma_f32_32x32x16_bf16 v[128:143], v[232:235], v[168:171], v[128:143]
    ds_read_b64_tr_b16 v[228:229], v21 offset:0
    ds_read_b64_tr_b16 v[230:231], v21 offset:2048
    v_cvt_pk_bf16_f32 v216, v32, v33
    v_exp_f32 v36, v148
    v_exp_f32 v37, v149
    s_waitcnt lgkmcnt(8)
    v_mfma_f32_32x32x16_bf16 v[128:143], v[236:239], v[172:175], v[128:143]
    ds_read_b64_tr_b16 v[232:233], v22 offset:0
    ds_read_b64_tr_b16 v[234:235], v22 offset:2048
    v_add_f32 v30, v32, v34
    v_add_f32 v31, v33, v35
    s_waitcnt lgkmcnt(9)
    v_mfma_f32_32x32x16_bf16 v[128:143], v[240:243], v[176:179], v[128:143]
    ds_read_b64_tr_b16 v[236:237], v23 offset:0
    ds_read_b64_tr_b16 v[238:239], v23 offset:2048
    v_cvt_pk_bf16_f32 v217, v34, v35
    v_exp_f32 v38, v150
    v_exp_f32 v39, v151
    s_waitcnt lgkmcnt(10)
    v_mfma_f32_32x32x16_bf16 v[128:143], v[244:247], v[180:183], v[128:143]
    ds_read_b64_tr_b16 v[240:241], v20 offset:4096
    ds_read_b64_tr_b16 v[242:243], v20 offset:6144
    v_add_f32 v30, v30, v36
    v_add_f32 v31, v31, v37
    s_waitcnt lgkmcnt(11)
    v_mfma_f32_32x32x16_bf16 v[128:143], v[248:251], v[184:187], v[128:143]
    ds_read_b64_tr_b16 v[244:245], v21 offset:4096
    ds_read_b64_tr_b16 v[246:247], v21 offset:6144
    v_cvt_pk_bf16_f32 v218, v36, v37
    v_exp_f32 v32, v152
    v_exp_f32 v33, v153
    s_waitcnt lgkmcnt(12)
    v_mfma_f32_32x32x16_bf16 v[128:143], v[252:255], v[188:191], v[128:143]
    ds_read_b64_tr_b16 v[248:249], v22 offset:4096
    ds_read_b64_tr_b16 v[250:251], v22 offset:6144
    v_add_f32 v30, v30, v38
    v_add_f32 v31, v31, v39
    s_waitcnt lgkmcnt(12)
    v_mfma_f32_32x32x16_bf16 v[64:79], v[224:227], v[208:211], v[64:79]
    ds_read_b64_tr_b16 v[252:253], v23 offset:4096
    ds_read_b64_tr_b16 v[254:255], v23 offset:6144
    v_cvt_pk_bf16_f32 v219, v38, v39
    v_exp_f32 v34, v154
    s_waitcnt lgkmcnt(12)
    v_mfma_f32_32x32x16_bf16 v[80:95], v[228:231], v[208:211], v[80:95]
    v_exp_f32 v35, v155
    v_add_f32 v30, v30, v32
    v_add_f32 v31, v31, v33
    s_waitcnt lgkmcnt(10)
    v_mfma_f32_32x32x16_bf16 v[96:111], v[232:235], v[208:211], v[96:111]
    v_cvt_pk_bf16_f32 v220, v32, v33
    v_exp_f32 v36, v156
    s_waitcnt lgkmcnt(8)
    v_mfma_f32_32x32x16_bf16 v[112:127], v[236:239], v[208:211], v[112:127]
    v_exp_f32 v37, v157
    v_add_f32 v30, v30, v34
    v_add_f32 v31, v31, v35
    s_waitcnt vmcnt(6) lgkmcnt(0)
    s_barrier
    ds_read_b128 v[224:227], v12 offset:24576
    ds_read_b128 v[228:231], v13 offset:24576
    ds_read_b128 v[232:235], v14 offset:24576
    v_mfma_f32_32x32x16_bf16 v[64:79], v[240:243], v[212:215], v[64:79]
    ds_read_b128 v[236:239], v15 offset:24576
    s_add_u32 s14, s9, 1
    s_and_b32 s14, s14, 7
    s_add_u32 s15, s74, 1
    s_and_b32 s15, s15, 24
    s_or_b32 s14, s14, s15
    s_lshl_b32 s14, s14, 14
    s_add_u32 s75, s14, s73
    s_add_u32 m0, s69, 40960
    s_nop 0
    buffer_load_dwordx4 v27, s[56:59], s75 offen offset:0 lds
    v_cvt_pk_bf16_f32 v221, v34, v35
    v_exp_f32 v38, v158
    v_mfma_f32_32x32x16_bf16 v[80:95], v[244:247], v[212:215], v[80:95]
    ds_read_b128 v[240:243], v16 offset:24576
    buffer_load_dwordx4 v28, s[56:59], s75 offen offset:1024 lds
    v_exp_f32 v39, v159
    v_add_f32 v30, v30, v36
    v_add_f32 v31, v31, v37
    v_mfma_f32_32x32x16_bf16 v[96:111], v[248:251], v[212:215], v[96:111]
    ds_read_b128 v[244:247], v17 offset:24576
    s_cmp_ge_u32 s3, 4
    s_cbranch_scc1 L_clr
L_clrr:
    v_cvt_pk_bf16_f32 v222, v36, v37
    v_add_f32 v30, v30, v38
    v_mfma_f32_32x32x16_bf16 v[112:127], v[252:255], v[212:215], v[112:127]
    ds_read_b128 v[248:251], v18 offset:24576
    v_add_f32 v31, v31, v39
    v_cvt_pk_bf16_f32 v223, v38, v39
    v_add_f32 v30, v30, v31
    s_mov_b32 s72, 13
    v_cmp_nge_f32 vcc, s71, v30
    s_cbranch_vccnz L_slow1
L_back13:
    v_add_f32 v29, v29, v30
    s_waitcnt lgkmcnt(6)
    v_mfma_f32_32x32x16_bf16 v[144:159], v[224:227], v[160:163], v[192:207]
    ds_read_b128 v[252:255], v19 offset:24576
    v_exp_f32 v32, v128
    v_exp_f32 v33, v129
    s_waitcnt lgkmcnt(6)
    v_mfma_f32_32x32x16_bf16 v[144:159], v[228:231], v[164:167], v[144:159]
    ds_read_b64_tr_b16 v[224:225], v20 offset:8192
    ds_read_b64_tr_b16 v[226:227], v20 offset:10240
    v_exp_f32 v34, v130
    v_exp_f32 v35, v131
    s_waitcnt lgkmcnt(7)
    v_mfma_f32_32x32x16_bf16 v[144:159], v[232:235], v[168:171], v[144:159]
    ds_read_b64_tr_b16 v[228:229], v21 offset:8192
    ds_read_b64_tr_b16 v[230:231], v21 offset:10240
    v_cvt_pk_bf16_f32 v208, v32, v33
    v_exp_f32 v36, v132
    v_exp_f32 v37, v133
    s_waitcnt lgkmcnt(8)
    v_mfma_f32_32x32x16_bf16 v[144:159], v[236:239], v[172:175], v[144:159]
    ds_read_b64_tr_b16 v[232:233], v22 offset:8192
    ds_read_b64_tr_b16 v[234:235], v22 offset:10240
    v_add_f32 v30, v32, v34
    v_add_f32 v31, v33, v35
    s_waitcnt lgkmcnt(9)
    v_mfma_f32_32x32x16_bf16 v[144:159], v[240:243], v[176:179], v[144:159]
    ds_read_b64_tr_b16 v[236:237], v23 offset:8192
    ds_read_b64_tr_b16 v[238:239], v23 offset:10240
    v_cvt_pk_bf16_f32 v209, v34, v35
    v_exp_f32 v38, v134
    v_exp_f32 v39, v135
    s_waitcnt lgkmcnt(10)
    v_mfma_f32_32x32x16_bf16 v[144:159], v[244:247], v[180:183], v[144:159]
    ds_read_b64_tr_b16 v[240:241], v20 offset:12288
    ds_read_b64_tr_b16 v[242:243], v20 offset:14336
    v_add_f32 v30, v30, v36
    v_add_f32 v31, v31, v37
    s_waitcnt lgkmcnt(11)
    v_mfma_f32_32x32x16_bf16 v[144:159], v[248:251], v[184:187], v[144:159]
    ds_read_b64_tr_b16 v[244:245], v21 offset:12288
    ds_read_b64_tr_b16 v[246:247], v21 offset:14336
    v_cvt_pk_bf16_f32 v210, v36, v37
    v_exp_f32 v32, v136
    v_exp_f32 v33, v137
    s_waitcnt lgkmcnt(12)
    v_mfma_f32_32x32x16_bf16 v[144:159], v[252:255], v[188:191], v[144:159]
    ds_read_b64_tr_b16 v[248:249], v22 offset:12288
    ds_read_b64_tr_b16 v[250:251], v22 offset:14336
    v_add_f32 v30, v30, v38
    v_add_f32 v31, v31, v39
    s_waitcnt lgkmcnt(12)
    v_mfma_f32_32x32x16_bf16 v[64:79], v[224:227], v[216:219], v[64:79]
    ds_read_b64_tr_b16 v[252:253], v23 offset:12288
    ds_read_b64_tr_b16 v[254:255], v23 offset:14336
    v_cvt_pk_bf16_f32 v211, v38, v39
    v_exp_f32 v34, v138
    s_waitcnt lgkmcnt(12)
    v_mfma_f32_32x32x16_bf16 v[80:95], v[228:231], v[216:219], v[80:95]
    v_exp_f32 v35, v139
    v_add_f32 v30, v30, v32
    v_add_f32 v31, v31, v33
    s_waitcnt lgkmcnt(10)
    v_mfma_f32_32x32x16_bf16 v[96:111], v[232:235], v[216:219], v[96:111]
    v_cvt_pk_bf16_f32 v212, v32, v33
    v_exp_f32 v36, v140
    s_waitcnt lgkmcnt(8)
    v_mfma_f32_32x32x16_bf16 v[112:127], v[236:239], v[216:219], v[112:127]
    v_exp_f32 v37, v141
    v_add_f32 v30, v30, v34
    v_add_f32 v31, v31, v35
    s_waitcnt vmcnt(6) lgkmcnt(0)
    s_barrier
    ds_read_b64_tr_b16 v[224:225], v20 offset:16384
    ds_read_b64_tr_b16 v[226:227], v20 offset:18432
    ds_read_b64_tr_b16 v[228:229], v21 offset:16384
    ds_read_b64_tr_b16 v[230:231], v21 offset:18432
    ds_read_b64_tr_b16 v[232:233], v22 offset:16384
    ds_read_b64_tr_b16 v[234:235], v22 offset:18432
    v_mfma_f32_32x32x16_bf16 v[64:79], v[240:243], v[220:223], v[64:79]
    ds_read_b64_tr_b16 v[236:237], v23 offset:16384
    ds_read_b64_tr_b16 v[238:239], v23 offset:18432
    s_add_u32 s14, s9, 2
    s_and_b32 s14, s14, 7
    s_add_u32 s15, s74, 2
    s_and_b32 s15, s15, 24
    s_or_b32 s14, s14, s15
    s_lshl_b32 s14, s14, 14
    s_add_u32 s75, s14, s73
    s_add_u32 m0, s69, 0
    s_nop 0
    buffer_load_dwordx4 v27, s[56:59], s75 offen offset:0 lds
    v_cvt_pk_bf16_f32 v213, v34, v35
    v_exp_f32 v38, v142
    v_mfma_f32_32x32x16_bf16 v[80:95], v[244:247], v[220:223], v[80:95]
    ds_read_b64_tr_b16 v[240:241], v20 offset:20480
    ds_read_b64_tr_b16 v[242:243], v20 offset:22528
    buffer_load_dwordx4 v28, s[56:59], s75 offen offset:1024 lds
    v_exp_f32 v39, v143
    v_add_f32 v30, v30, v36
    v_add_f32 v31, v31, v37
    v_mfma_f32_32x32x16_bf16 v[96:111], v[248:251], v[220:223], v[96:111]
    ds_read_b64_tr_b16 v[244:245], v21 offset:20480
    ds_read_b64_tr_b16 v[246:247], v21 offset:22528
    v_cvt_pk_bf16_f32 v214, v36, v37
    v_add_f32 v30, v30, v38
    v_mfma_f32_32x32x16_bf16 v[112:127], v[252:255], v[220:223], v[112:127]
    ds_read_b64_tr_b16 v[248:249], v22 offset:20480
    ds_read_b64_tr_b16 v[250:251], v22 offset:22528
    v_add_f32 v31, v31, v39
    v_cvt_pk_bf16_f32 v215, v38, v39
    v_add_f32 v30, v30, v31
    s_mov_b32 s72, 14
    v_cmp_nge_f32 vcc, s71, v30
    s_cbranch_vccnz L_slow0
L_back14:
    v_add_f32 v29, v29, v30
    s_waitcnt lgkmcnt(12)
    v_mfma_f32_32x32x16_bf16 v[64:79], v[224:227], v[208:211], v[64:79]
    ds_read_b64_tr_b16 v[252:253], v23 offset:20480
    ds_read_b64_tr_b16 v[254:255], v23 offset:22528
    v_exp_f32 v32, v144
    v_exp_f32 v33, v145
    v_exp_f32 v34, v146
    v_exp_f32 v35, v147
    s_waitcnt lgkmcnt(12)
    v_mfma_f32_32x32x16_bf16 v[80:95], v[228:231], v[208:211], v[80:95]
    v_cvt_pk_bf16_f32 v216, v32, v33
    v_exp_f32 v36, v148
    v_exp_f32 v37, v149
    v_add_f32 v30, v32, v34
    v_add_f32 v31, v33, v35
    s_waitcnt lgkmcnt(10)
    v_mfma_f32_32x32x16_bf16 v[96:111], v[232:235], v[208:211], v[96:111]
    v_cvt_pk_bf16_f32 v217, v34, v35
    v_exp_f32 v38, v150
    v_exp_f32 v39, v151
    v_add_f32 v30, v30, v36
    v_add_f32 v31, v31, v37
    s_waitcnt lgkmcnt(8)
    v_mfma_f32_32x32x16_bf16 v[112:127], v[236:239], v[208:211], v[112:127]
    v_cvt_pk_bf16_f32 v218, v36, v37
    v_exp_f32 v32, v152
    v_exp_f32 v33, v153
    v_add_f32 v30, v30, v38
    v_add_f32 v31, v31, v39
    s_waitcnt vmcnt(6) lgkmcnt(0)
    s_barrier
    ds_read_b64_tr_b16 v[224:225], v20 offset:24576
    ds_read_b64_tr_b16 v[226:227], v20 offset:26624
    ds_read_b64_tr_b16 v[228:229], v20 offset:28672
    ds_read_b64_tr_b16 v[230:231], v20 offset:30720
    ds_read_b64_tr_b16 v[232:233], v21 offset:24576
    ds_read_b64_tr_b16 v[234:235], v21 offset:26624
    v_mfma_f32_32x32x16_bf16 v[64:79], v[240:243], v[212:215], v[64:79]
    ds_read_b64_tr_b16 v[236:237], v21 offset:28672
    ds_read_b64_tr_b16 v[238:239], v21 offset:30720
    s_add_u32 s14, s9, 3
    s_and_b32 s14, s14, 7
    s_add_u32 s15, s74, 3
    s_and_b32 s15, s15, 24
    s_or_b32 s14, s14, s15
    s_lshl_b32 s14, s14, 14
    s_add_u32 s75, s14, s73
    s_add_u32 m0, s69, 8192
    s_nop 0
    buffer_load_dwordx4 v27, s[56:59], s75 offen offset:0 lds
    v_cvt_pk_bf16_f32 v219, v38, v39
    v_exp_f32 v34, v154
    v_exp_f32 v35, v155
    v_add_f32 v30, v30, v32
    v_add_f32 v31, v31, v33
    v_mfma_f32_32x32x16_bf16 v[80:95], v[244:247], v[212:215], v[80:95]
    ds_read_b64_tr_b16 v[240:241], v22 offset:24576
    ds_read_b64_tr_b16 v[242:243], v22 offset:26624
    buffer_load_dwordx4 v28, s[56:59], s75 offen offset:1024 lds
    v_cvt_pk_bf16_f32 v220, v32, v33
    v_exp_f32 v36, v156
    v_exp_f32 v37, v157
    v_add_f32 v30, v30, v34
    v_add_f32 v31, v31, v35
    v_mfma_f32_32x32x16_bf16 v[96:111], v[248:251], v[212:215], v[96:111]
    ds_read_b64_tr_b16 v[244:245], v22 offset:28672
    ds_read_b64_tr_b16 v[246:247], v22 offset:30720
    s_add_u32 s14, s9, 4
    s_and_b32 s14, s14, 7
    s_add_u32 s15, s74, 4
    s_and_b32 s15, s15, 24
    s_or_b32 s14, s14, s15
    s_lshl_b32 s14, s14, 14
    s_add_u32 s75, s14, s73
    s_add_u32 m0, s69, 16384
    s_nop 0
    buffer_load_dwordx4 v27, s[56:59], s75 offen offset:0 lds
    v_cvt_pk_bf16_f32 v221, v34, v35
    v_exp_f32 v38, v158
    v_exp_f32 v39, v159
    v_add_f32 v30, v30, v36
    v_add_f32 v31, v31, v37
    v_mfma_f32_32x32x16_bf16 v[112:127], v[252:255], v[212:215], v[112:127]
    ds_read_b64_tr_b16 v[248:249], v23 offset:24576
    ds_read_b64_tr_b16 v[250:251], v23 offset:26624
    buffer_load_dwordx4 v28, s[56:59], s75 offen offset:1024 lds
    v_cvt_pk_bf16_f32 v222, v36, v37
    v_add_f32 v30, v30, v38
    v_add_f32 v31, v31, v39
    v_cvt_pk_bf16_f32 v223, v38, v39
    v_add_f32 v30, v30, v31
    s_mov_b32 s72, 15
    v_cmp_nge_f32 vcc, s71, v30
    s_cbranch_vccnz L_slow1
L_back15:
    v_add_f32 v29, v29, v30
    v_mov_b32 v40, v29
    v_lshrrev_b32 v42, 5, v1
    v_and_b32 v43, 15, v1
    v_permlane32_swap_b32 v40, v29
    v_lshlrev_b32 v42, 1, v42
    v_xor_b32 v42, v42, v43
    v_add_f32 v29, v29, v40
    v_rcp_f32 v30, v29
    s_waitcnt lgkmcnt(12)
    v_mfma_f32_32x32x16_bf16 v[64:79], v[224:227], v[216:219], v[64:79]
    ds_read_b64_tr_b16 v[252:253], v23 offset:28672
    ds_read_b64_tr_b16 v[254:255], v23 offset:30720
    s_add_u32 s14, s9, 5
    s_and_b32 s14, s14, 7
    s_add_u32 s15, s74, 5
    s_and_b32 s15, s15, 24
    s_or_b32 s14, s14, s15
    s_lshl_b32 s14, s14, 14
    s_add_u32 s75, s14, s73
    s_add_u32 m0, s69, 24576
    s_nop 0
    buffer_load_dwordx4 v27, s[56:59], s75 offen offset:0 lds
    s_waitcnt lgkmcnt(12)
    v_mfma_f32_32x32x16_bf16 v[64:79], v[228:231], v[220:223], v[64:79]
    buffer_load_dwordx4 v28, s[56:59], s75 offen offset:1024 lds
    s_waitcnt lgkmcnt(10)
    v_mfma_f32_32x32x16_bf16 v[80:95], v[232:235], v[216:219], v[80:95]
    s_waitcnt lgkmcnt(8)
    v_mfma_f32_32x32x16_bf16 v[80:95], v[236:239], v[220:223], v[80:95]
    s_waitcnt lgkmcnt(0)
    s_barrier
    v_lshlrev_b32 v42, 4, v42
    v_and_b32 v43, 31, v1
    v_lshl_add_u32 v42, v43, 8, v42
    s_lshr_b32 s14, s74, 3
    s_sub_u32 s14, s42, s14
    s_and_b32 s14, s14, 3
    s_lshl_b32 s14, s14, 13
    s_lshl_b32 s15, s43, 15
    s_add_u32 s14, s14, s15
    s_add_u32 s72, s14, 98304
    v_add_u32 v12, s72, v42
    v_xor_b32 v13, 16, v12
    v_xor_b32 v14, 64, v12
    v_xor_b32 v15, 80, v12
    v_xor_b32 v16, 128, v12
    v_xor_b32 v17, 144, v12
    v_xor_b32 v18, 192, v12
    v_xor_b32 v19, 208, v12
    v_mov_b32 v31, v30
    v_mul_f32 v64, v30, v64
    v_mul_f32 v65, v30, v65
    v_mul_f32 v66, v30, v66
    v_mul_f32 v67, v30, v67
    v_mul_f32 v68, v30, v68
    v_mul_f32 v69, v30, v69
    v_mul_f32 v70, v30, v70
    v_mul_f32 v71, v30, v71
    v_mul_f32 v72, v30, v72
    v_mul_f32 v73, v30, v73
    v_mul_f32 v74, v30, v74
    v_mul_f32 v75, v30, v75
    v_mul_f32 v76, v30, v76
    v_mul_f32 v77, v30, v77
    v_mul_f32 v78, v30, v78
    v_mul_f32 v79, v30, v79
    v_cvt_pk_bf16_f32 v128, v64, v65
    v_cvt_pk_bf16_f32 v129, v66, v67
    v_cvt_pk_bf16_f32 v130, v68, v69
    v_cvt_pk_bf16_f32 v131, v70, v71
    v_cvt_pk_bf16_f32 v132, v72, v73
    v_cvt_pk_bf16_f32 v133, v74, v75
    v_cvt_pk_bf16_f32 v134, v76, v77
    v_cvt_pk_bf16_f32 v135, v78, v79
    ds_write_b128 v12, v[128:131]
    ds_write_b128 v13, v[132:135]
    v_mfma_f32_32x32x16_bf16 v[96:111], v[240:243], v[216:219], v[96:111]
    v_mfma_f32_32x32x16_bf16 v[96:111], v[244:247], v[220:223], v[96:111]
    v_mul_f32 v80, v30, v80
    v_mul_f32 v81, v30, v81
    v_mul_f32 v82, v30, v82
    v_mul_f32 v83, v30, v83
    v_mul_f32 v84, v30, v84
    v_mul_f32 v85, v30, v85
    v_mul_f32 v86, v30, v86
    v_mul_f32 v87, v30, v87
    v_mul_f32 v88, v30, v88
    v_mul_f32 v89, v30, v89
    v_mul_f32 v90, v30, v90
    v_mul_f32 v91, v30, v91
    v_mul_f32 v92, v30, v92
    v_mul_f32 v93, v30, v93
    v_mul_f32 v94, v30, v94
    v_mul_f32 v95, v30, v95
    v_cvt_pk_bf16_f32 v136, v80, v81
    v_cvt_pk_bf16_f32 v137, v82, v83
    v_cvt_pk_bf16_f32 v138, v84, v85
    v_cvt_pk_bf16_f32 v139, v86, v87
    v_cvt_pk_bf16_f32 v140, v88, v89
    v_cvt_pk_bf16_f32 v141, v90, v91
    v_cvt_pk_bf16_f32 v142, v92, v93
    v_cvt_pk_bf16_f32 v143, v94, v95
    ds_write_b128 v14, v[136:139]
    ds_write_b128 v15, v[140:143]
    v_mfma_f32_32x32x16_bf16 v[112:127], v[248:251], v[216:219], v[112:127]
    v_mfma_f32_32x32x16_bf16 v[112:127], v[252:255], v[220:223], v[112:127]
    v_mul_f32 v96, v30, v96
    v_mul_f32 v97, v30, v97
    v_mul_f32 v98, v30, v98
    v_mul_f32 v99, v30, v99
    v_mul_f32 v100, v30, v100
    v_mul_f32 v101, v30, v101
    v_mul_f32 v102, v30, v102
    v_mul_f32 v103, v30, v103
    v_mul_f32 v104, v30, v104
    v_mul_f32 v105, v30, v105
    v_mul_f32 v106, v30, v106
    v_mul_f32 v107, v30, v107
    v_mul_f32 v108, v30, v108
    v_mul_f32 v109, v30, v109
    v_mul_f32 v110, v30, v110
    v_mul_f32 v111, v30, v111
    v_cvt_pk_bf16_f32 v144, v96, v97
    v_cvt_pk_bf16_f32 v145, v98, v99
    v_cvt_pk_bf16_f32 v146, v100, v101
    v_cvt_pk_bf16_f32 v147, v102, v103
    v_cvt_pk_bf16_f32 v148, v104, v105
    v_cvt_pk_bf16_f32 v149, v106, v107
    v_cvt_pk_bf16_f32 v150, v108, v109
    v_cvt_pk_bf16_f32 v151, v110, v111
    ds_write_b128 v16, v[144:147]
    ds_write_b128 v17, v[148:151]
    v_mul_f32 v112, v30, v112
    v_mul_f32 v113, v30, v113
    v_mul_f32 v114, v30, v114
    v_mul_f32 v115, v30, v115
    v_mul_f32 v116, v30, v116
    v_mul_f32 v117, v30, v117
    v_mul_f32 v118, v30, v118
    v_mul_f32 v119, v30, v119
    v_mul_f32 v120, v30, v120
    v_mul_f32 v121, v30, v121
    v_mul_f32 v122, v30, v122
    v_mul_f32 v123, v30, v123
    v_mul_f32 v124, v30, v124
    v_mul_f32 v125, v30, v125
    v_mul_f32 v126, v30, v126
    v_mul_f32 v127, v30, v127
    v_cvt_pk_bf16_f32 v152, v112, v113
    v_cvt_pk_bf16_f32 v153, v114, v115
    v_cvt_pk_bf16_f32 v154, v116, v117
    v_cvt_pk_bf16_f32 v155, v118, v119
    v_cvt_pk_bf16_f32 v156, v120, v121
    v_cvt_pk_bf16_f32 v157, v122, v123
    v_cvt_pk_bf16_f32 v158, v124, v125
    v_cvt_pk_bf16_f32 v159, v126, v127
    ds_write_b128 v18, v[152:155]
    ds_write_b128 v19, v[156:159]
    s_lshl_b32 s14, s9, 5
    s_cmp_lt_u32 s3, 4
    s_cselect_b32 s9, s14, s9
    s_cbranch_scc1 L_phase

    s_mov_b32 s8, 6
    s_add_u32 s11, s79, 32768
    s_add_u32 s12, s79, 49152
    s_add_u32 s14, s9, 6
    s_and_b32 s14, s14, 7
    s_add_u32 s15, s74, 6
    s_and_b32 s15, s15, 24
    s_or_b32 s14, s14, s15
    s_lshl_b32 s14, s14, 14
    s_add_u32 s72, s14, s78
    s_waitcnt vmcnt(0) lgkmcnt(0)
    s_barrier
L_wo:
    s_mov_b32 m0, s11
    s_mov_b32 s75, s72
    s_waitcnt vmcnt(16)
    s_barrier

    buffer_load_dwordx4 v50, s[56:59], s75 offen offset:0 lds
    s_add_u32 s11, s11, 8192
    s_cmp_eq_u32 s11, s12
    s_cselect_b32 s11, s79, s11
    s_add_u32 s8, s8, 1

    buffer_load_dwordx4 v51, s[56:59], s75 offen offset:1024 lds
    s_add_u32 s14, s9, s8
    s_and_b32 s14, s14, 7
    s_add_u32 s15, s74, s8
    s_and_b32 s15, s15, 24
    s_or_b32 s14, s14, s15
    s_lshl_b32 s14, s14, 14
    s_add_u32 s72, s14, s78
    s_cmp_lt_u32 s8, 32
    buffer_load_dwordx4 v52, s[56:59], s75 offen offset:2048 lds
    buffer_load_dwordx4 v53, s[56:59], s75 offen offset:3072 lds
    s_cbranch_scc1 L_wo
    s_waitcnt vmcnt(16)
    s_barrier
    s_waitcnt vmcnt(12)
    s_barrier
    s_waitcnt vmcnt(8)
    s_barrier
    s_waitcnt vmcnt(4)
    s_barrier
    s_waitcnt vmcnt(0)
    s_barrier
    s_branch L_ec
L_ec2:
    buffer_load_dword v11, off, s[24:27], s21 sc1
L_ec:
    s_add_u32 s8, s8, 1
    s_waitcnt vmcnt(0)
    v_readfirstlane_b32 s14, v11
    s_cmp_ge_u32 s14, 4
    s_cbranch_scc1 L_ec3
    s_cmp_lt_u32 s8, 131072
    s_cbranch_scc1 L_ec2

L_ec3:
    s_barrier
    s_cmp_eq_u32 s10, 0
    s_cbranch_scc1 L_red2
    s_branch L_fin

L_otail:
    v_mfma_f32_32x32x16_bf16 v[176:191], v[100:103], v[108:111], v[176:191]
    v_cvt_pk_bf16_f32 v128, v128, v129
    v_cvt_pk_bf16_f32 v129, v130, v131
    v_cvt_pk_bf16_f32 v130, v132, v133
    v_cvt_pk_bf16_f32 v131, v134, v135
    v_cvt_pk_bf16_f32 v132, v136, v137
    v_cvt_pk_bf16_f32 v133, v138, v139
    v_cvt_pk_bf16_f32 v134, v140, v141
    v_cvt_pk_bf16_f32 v135, v142, v143
    buffer_store_dwordx4 v[128:131], v49, s[60:63], s18 offen offset:0 sc1
    buffer_store_dwordx4 v[132:135], v49, s[60:63], s18 offen offset:1024 sc1
    v_mfma_f32_32x32x16_bf16 v[224:239], v[96:99], v[104:107], v[224:239]
    v_cvt_pk_bf16_f32 v192, v192, v193
    v_cvt_pk_bf16_f32 v193, v194, v195
    v_cvt_pk_bf16_f32 v194, v196, v197
    v_cvt_pk_bf16_f32 v195, v198, v199
    v_cvt_pk_bf16_f32 v196, v200, v201
    v_cvt_pk_bf16_f32 v197, v202, v203
    v_cvt_pk_bf16_f32 v198, v204, v205
    v_cvt_pk_bf16_f32 v199, v206, v207
    buffer_store_dwordx4 v[192:195], v49, s[60:63], s16 offen offset:0 sc1
    buffer_store_dwordx4 v[196:199], v49, s[60:63], s16 offen offset:1024 sc1
    v_mfma_f32_32x32x16_bf16 v[240:255], v[100:103], v[104:107], v[240:255]
    v_cvt_pk_bf16_f32 v144, v144, v145
    v_cvt_pk_bf16_f32 v145, v146, v147
    v_cvt_pk_bf16_f32 v146, v148, v149
    v_cvt_pk_bf16_f32 v147, v150, v151
    v_cvt_pk_bf16_f32 v148, v152, v153
    v_cvt_pk_bf16_f32 v149, v154, v155
    v_cvt_pk_bf16_f32 v150, v156, v157
    v_cvt_pk_bf16_f32 v151, v158, v159
    buffer_store_dwordx4 v[144:147], v49, s[60:63], s18 offen offset:2048 sc1
    buffer_store_dwordx4 v[148:151], v49, s[60:63], s18 offen offset:3072 sc1
    v_cvt_pk_bf16_f32 v208, v208, v209
    v_cvt_pk_bf16_f32 v209, v210, v211
    v_cvt_pk_bf16_f32 v210, v212, v213
    v_cvt_pk_bf16_f32 v211, v214, v215
    v_cvt_pk_bf16_f32 v212, v216, v217
    v_cvt_pk_bf16_f32 v213, v218, v219
    v_cvt_pk_bf16_f32 v214, v220, v221
    v_cvt_pk_bf16_f32 v215, v222, v223
    buffer_store_dwordx4 v[208:211], v49, s[60:63], s16 offen offset:2048 sc1
    buffer_store_dwordx4 v[212:215], v49, s[60:63], s16 offen offset:3072 sc1
    v_cvt_pk_bf16_f32 v160, v160, v161
    v_cvt_pk_bf16_f32 v161, v162, v163
    v_cvt_pk_bf16_f32 v162, v164, v165
    v_cvt_pk_bf16_f32 v163, v166, v167
    v_cvt_pk_bf16_f32 v164, v168, v169
    v_cvt_pk_bf16_f32 v165, v170, v171
    v_cvt_pk_bf16_f32 v166, v172, v173
    v_cvt_pk_bf16_f32 v167, v174, v175
    buffer_store_dwordx4 v[160:163], v49, s[60:63], s19 offen offset:0 sc1
    buffer_store_dwordx4 v[164:167], v49, s[60:63], s19 offen offset:1024 sc1
    v_cvt_pk_bf16_f32 v176, v176, v177
    v_cvt_pk_bf16_f32 v177, v178, v179
    v_cvt_pk_bf16_f32 v178, v180, v181
    v_cvt_pk_bf16_f32 v179, v182, v183
    v_cvt_pk_bf16_f32 v180, v184, v185
    v_cvt_pk_bf16_f32 v181, v186, v187
    v_cvt_pk_bf16_f32 v182, v188, v189
    v_cvt_pk_bf16_f32 v183, v190, v191
    buffer_store_dwordx4 v[176:179], v49, s[60:63], s19 offen offset:2048 sc1
    buffer_store_dwordx4 v[180:183], v49, s[60:63], s19 offen offset:3072 sc1
    v_cvt_pk_bf16_f32 v224, v224, v225
    v_cvt_pk_bf16_f32 v225, v226, v227
    v_cvt_pk_bf16_f32 v226, v228, v229
    v_cvt_pk_bf16_f32 v227, v230, v231
    v_cvt_pk_bf16_f32 v228, v232, v233
    v_cvt_pk_bf16_f32 v229, v234, v235
    v_cvt_pk_bf16_f32 v230, v236, v237
    v_cvt_pk_bf16_f32 v231, v238, v239
    buffer_store_dwordx4 v[224:227], v49, s[60:63], s17 offen offset:0 sc1
    buffer_store_dwordx4 v[228:231], v49, s[60:63], s17 offen offset:1024 sc1
    v_cvt_pk_bf16_f32 v240, v240, v241
    v_cvt_pk_bf16_f32 v241, v242, v243
    v_cvt_pk_bf16_f32 v242, v244, v245
    v_cvt_pk_bf16_f32 v243, v246, v247
    v_cvt_pk_bf16_f32 v244, v248, v249
    v_cvt_pk_bf16_f32 v245, v250, v251
    v_cvt_pk_bf16_f32 v246, v252, v253
    v_cvt_pk_bf16_f32 v247, v254, v255
    buffer_store_dwordx4 v[240:243], v49, s[60:63], s17 offen offset:2048 sc1
    buffer_store_dwordx4 v[244:247], v49, s[60:63], s17 offen offset:3072 sc1
    s_and_b32 s14, s34, 0xffffe000
    s_xor_b32 s14, s14, 0x2000
    s_lshl_b32 s15, s3, 11
    s_add_u32 s14, s14, s15
    s_lshl_b32 s15, s4, 7
    s_add_u32 s14, s14, s15
    v_mov_b32 v47, 0
    s_mov_b64 exec, 1
    s_waitcnt vmcnt(0)
    buffer_store_dword v47, off, s[60:63], s14 sc1
    s_mov_b64 exec, -1
    s_cmp_lg_u32 s10, 0
    s_cbranch_scc1 L_fin

L_red2:
    v_and_b32 v5, 7, v1
    v_lshrrev_b32 v6, 3, v1
    v_lshlrev_b32 v2, 10, v5
    v_lshl_add_u32 v2, v6, 4, v2
    v_lshlrev_b32 v3, 11, v6
    v_lshl_add_u32 v3, v5, 4, v3
    v_lshlrev_b32 v4, 7, v5
    v_mov_b32 v5, -1
    s_and_b32 s14, s2, 0xf8
    s_xor_b32 s14, s14, 8
    s_lshl_b32 s14, s14, 16
    s_lshl_b32 s15, s4, 13
    s_add_u32 s14, s14, s15
    s_lshl_b32 s15, s43, 13
    s_add_u32 s14, s14, s15
    s_lshl_b32 s15, s42, 7
    s_add_u32 s68, s14, s15

    s_add_u32 s69, s68, 65536
    s_add_u32 s70, s68, 131072
    s_add_u32 s71, s68, 196608
    s_add_u32 s72, s68, 262144
    s_add_u32 s73, s68, 327680
    s_add_u32 s74, s68, 393216
    s_add_u32 s75, s68, 458752
    s_lshl_b32 s97, s7, 17
    s_lshl_b32 s14, s3, 14
    s_add_u32 s97, s97, s14
    s_lshl_b32 s14, s6, 10
    s_xor_b32 s14, s14, 1024
    s_add_u32 s97, s97, s14
    s_lshl_b32 s14, s4, 7
    s_add_u32 s97, s97, s14
    s_mov_b32 s28, s36
    s_mov_b32 s29, s37
    s_mov_b32 s30, 0x200000
    s_mov_b32 s31, 0x00020000
    s_mov_b32 s23, 0xffff0000
    s_mov_b32 s98, 255
    s_mov_b32 s99, 0
    s_mov_b32 s8, 0
    s_mov_b32 s101, 0
    s_mov_b32 s100, -1

L_poll:
    s_mov_b32 exec_lo, s98
    s_mov_b32 exec_hi, 0
    buffer_load_dword v5, v4, s[60:63], s34 offen sc1
    s_waitcnt vmcnt(3)
    v_cmp_ne_u32 vcc, -1, v5
    s_mov_b64 exec, -1

    s_and_b32 s99, vcc_lo, s98
    s_cbranch_scc0 L_none
    s_andn2_b32 s98, s98, s99

    s_bitcmp1_b32 s99, 0
    s_cbranch_scc0 L_pl0
    buffer_load_dwordx4 v[16:19], v2, s[60:63], s68 offen offset:0 sc1
    buffer_load_dwordx4 v[20:23], v2, s[60:63], s68 offen offset:512 sc1
L_pl0:
    s_bitcmp1_b32 s99, 1
    s_cbranch_scc0 L_pl1
    buffer_load_dwordx4 v[24:27], v2, s[60:63], s69 offen offset:0 sc1
    buffer_load_dwordx4 v[28:31], v2, s[60:63], s69 offen offset:512 sc1
L_pl1:
    s_bitcmp1_b32 s99, 2
    s_cbranch_scc0 L_pl2
    buffer_load_dwordx4 v[32:35], v2, s[60:63], s70 offen offset:0 sc1
    buffer_load_dwordx4 v[36:39], v2, s[60:63], s70 offen offset:512 sc1
L_pl2:
    s_bitcmp1_b32 s99, 3
    s_cbranch_scc0 L_pl3
    buffer_load_dwordx4 v[40:43], v2, s[60:63], s71 offen offset:0 sc1
    buffer_load_dwordx4 v[44:47], v2, s[60:63], s71 offen offset:512 sc1
L_pl3:
    s_bitcmp1_b32 s99, 4
    s_cbranch_scc0 L_pl4
    buffer_load_dwordx4 v[48:51], v2, s[60:63], s72 offen offset:0 sc1
    buffer_load_dwordx4 v[52:55], v2, s[60:63], s72 offen offset:512 sc1
L_pl4:
    s_bitcmp1_b32 s99, 5
    s_cbranch_scc0 L_pl5
    buffer_load_dwordx4 v[56:59], v2, s[60:63], s73 offen offset:0 sc1
    buffer_load_dwordx4 v[60:63], v2, s[60:63], s73 offen offset:512 sc1
L_pl5:
    s_bitcmp1_b32 s99, 6
    s_cbranch_scc0 L_pl6
    buffer_load_dwordx4 v[64:67], v2, s[60:63], s74 offen offset:0 sc1
    buffer_load_dwordx4 v[68:71], v2, s[60:63], s74 offen offset:512 sc1
L_pl6:
    s_bitcmp1_b32 s99, 7
    s_cbranch_scc0 L_pl7
    buffer_load_dwordx4 v[72:75], v2, s[60:63], s75 offen offset:0 sc1
    buffer_load_dwordx4 v[76:79], v2, s[60:63], s75 offen offset:512 sc1
L_pl7:
    s_or_b32 s101, s101, s99
    s_add_u32 s100, s8, 3
L_none:
    s_cmp_lg_u32 s8, s100
    s_cbranch_scc1 L_noup
L_up:
    s_bitcmp1_b32 s101, 0
    s_cbranch_scc0 L_pu0
    v_lshlrev_b32 v96, 16, v16
    v_and_b32 v97, s23, v16
    v_lshlrev_b32 v98, 16, v17
    v_and_b32 v99, s23, v17
    v_lshlrev_b32 v100, 16, v18
    v_and_b32 v101, s23, v18
    v_lshlrev_b32 v102, 16, v19
    v_and_b32 v103, s23, v19
    v_lshlrev_b32 v104, 16, v20
    v_and_b32 v105, s23, v20
    v_lshlrev_b32 v106, 16, v21
    v_and_b32 v107, s23, v21
    v_lshlrev_b32 v108, 16, v22
    v_and_b32 v109, s23, v22
    v_lshlrev_b32 v110, 16, v23
    v_and_b32 v111, s23, v23
L_pu0:
    s_bitcmp1_b32 s101, 1
    s_cbranch_scc0 L_pu1
    v_lshlrev_b32 v112, 16, v24
    v_and_b32 v113, s23, v24
    v_lshlrev_b32 v114, 16, v25
    v_and_b32 v115, s23, v25
    v_lshlrev_b32 v116, 16, v26
    v_and_b32 v117, s23, v26
    v_lshlrev_b32 v118, 16, v27
    v_and_b32 v119, s23, v27
    v_lshlrev_b32 v120, 16, v28
    v_and_b32 v121, s23, v28
    v_lshlrev_b32 v122, 16, v29
    v_and_b32 v123, s23, v29
    v_lshlrev_b32 v124, 16, v30
    v_and_b32 v125, s23, v30
    v_lshlrev_b32 v126, 16, v31
    v_and_b32 v127, s23, v31
L_pu1:
    s_bitcmp1_b32 s101, 2
    s_cbranch_scc0 L_pu2
    v_lshlrev_b32 v128, 16, v32
    v_and_b32 v129, s23, v32
    v_lshlrev_b32 v130, 16, v33
    v_and_b32 v131, s23, v33
    v_lshlrev_b32 v132, 16, v34
    v_and_b32 v133, s23, v34
    v_lshlrev_b32 v134, 16, v35
    v_and_b32 v135, s23, v35
    v_lshlrev_b32 v136, 16, v36
    v_and_b32 v137, s23, v36
    v_lshlrev_b32 v138, 16, v37
    v_and_b32 v139, s23, v37
    v_lshlrev_b32 v140, 16, v38
    v_and_b32 v141, s23, v38
    v_lshlrev_b32 v142, 16, v39
    v_and_b32 v143, s23, v39
L_pu2:
    s_bitcmp1_b32 s101, 3
    s_cbranch_scc0 L_pu3
    v_lshlrev_b32 v144, 16, v40
    v_and_b32 v145, s23, v40
    v_lshlrev_b32 v146, 16, v41
    v_and_b32 v147, s23, v41
    v_lshlrev_b32 v148, 16, v42
    v_and_b32 v149, s23, v42
    v_lshlrev_b32 v150, 16, v43
    v_and_b32 v151, s23, v43
    v_lshlrev_b32 v152, 16, v44
    v_and_b32 v153, s23, v44
    v_lshlrev_b32 v154, 16, v45
    v_and_b32 v155, s23, v45
    v_lshlrev_b32 v156, 16, v46
    v_and_b32 v157, s23, v46
    v_lshlrev_b32 v158, 16, v47
    v_and_b32 v159, s23, v47
L_pu3:
    s_bitcmp1_b32 s101, 4
    s_cbranch_scc0 L_pu4
    v_lshlrev_b32 v160, 16, v48
    v_and_b32 v161, s23, v48
    v_lshlrev_b32 v162, 16, v49
    v_and_b32 v163, s23, v49
    v_lshlrev_b32 v164, 16, v50
    v_and_b32 v165, s23, v50
    v_lshlrev_b32 v166, 16, v51
    v_and_b32 v167, s23, v51
    v_lshlrev_b32 v168, 16, v52
    v_and_b32 v169, s23, v52
    v_lshlrev_b32 v170, 16, v53
    v_and_b32 v171, s23, v53
    v_lshlrev_b32 v172, 16, v54
    v_and_b32 v173, s23, v54
    v_lshlrev_b32 v174, 16, v55
    v_and_b32 v175, s23, v55
L_pu4:
    s_bitcmp1_b32 s101, 5
    s_cbranch_scc0 L_pu5
    v_lshlrev_b32 v176, 16, v56
    v_and_b32 v177, s23, v56
    v_lshlrev_b32 v178, 16, v57
    v_and_b32 v179, s23, v57
    v_lshlrev_b32 v180, 16, v58
    v_and_b32 v181, s23, v58
    v_lshlrev_b32 v182, 16, v59
    v_and_b32 v183, s23, v59
    v_lshlrev_b32 v184, 16, v60
    v_and_b32 v185, s23, v60
    v_lshlrev_b32 v186, 16, v61
    v_and_b32 v187, s23, v61
    v_lshlrev_b32 v188, 16, v62
    v_and_b32 v189, s23, v62
    v_lshlrev_b32 v190, 16, v63
    v_and_b32 v191, s23, v63
L_pu5:
    s_bitcmp1_b32 s101, 6
    s_cbranch_scc0 L_pu6
    v_lshlrev_b32 v192, 16, v64
    v_and_b32 v193, s23, v64
    v_lshlrev_b32 v194, 16, v65
    v_and_b32 v195, s23, v65
    v_lshlrev_b32 v196, 16, v66
    v_and_b32 v197, s23, v66
    v_lshlrev_b32 v198, 16, v67
    v_and_b32 v199, s23, v67
    v_lshlrev_b32 v200, 16, v68
    v_and_b32 v201, s23, v68
    v_lshlrev_b32 v202, 16, v69
    v_and_b32 v203, s23, v69
    v_lshlrev_b32 v204, 16, v70
    v_and_b32 v205, s23, v70
    v_lshlrev_b32 v206, 16, v71
    v_and_b32 v207, s23, v71
L_pu6:
    s_bitcmp1_b32 s101, 7
    s_cbranch_scc0 L_pu7
    v_lshlrev_b32 v208, 16, v72
    v_and_b32 v209, s23, v72
    v_lshlrev_b32 v210, 16, v73
    v_and_b32 v211, s23, v73
    v_lshlrev_b32 v212, 16, v74
    v_and_b32 v213, s23, v74
    v_lshlrev_b32 v214, 16, v75
    v_and_b32 v215, s23, v75
    v_lshlrev_b32 v216, 16, v76
    v_and_b32 v217, s23, v76
    v_lshlrev_b32 v218, 16, v77
    v_and_b32 v219, s23, v77
    v_lshlrev_b32 v220, 16, v78
    v_and_b32 v221, s23, v78
    v_lshlrev_b32 v222, 16, v79
    v_and_b32 v223, s23, v79
L_pu7:
    s_mov_b32 s101, 0
L_noup:
    s_cmp_eq_u32 s98, 0
    s_cbranch_scc1 L_last
    s_add_u32 s8, s8, 1

    s_cmp_lt_u32 s8, 1048576
    s_cbranch_scc1 L_poll
    s_mov_b32 s98, 0

L_last:

    s_mov_b32 s99, 0
    s_cmp_lg_u32 s101, 0
    s_waitcnt vmcnt(0)
    s_cbranch_scc1 L_up

    v_pk_add_f32 v[96:97], v[96:97], v[112:113]
    v_pk_add_f32 v[98:99], v[98:99], v[114:115]
    v_pk_add_f32 v[100:101], v[100:101], v[116:117]
    v_pk_add_f32 v[102:103], v[102:103], v[118:119]
    v_pk_add_f32 v[104:105], v[104:105], v[120:121]
    v_pk_add_f32 v[106:107], v[106:107], v[122:123]
    v_pk_add_f32 v[108:109], v[108:109], v[124:125]
    v_pk_add_f32 v[110:111], v[110:111], v[126:127]
    v_pk_add_f32 v[128:129], v[128:129], v[144:145]
    v_pk_add_f32 v[130:131], v[130:131], v[146:147]
    v_pk_add_f32 v[132:133], v[132:133], v[148:149]
    v_pk_add_f32 v[134:135], v[134:135], v[150:151]
    v_pk_add_f32 v[136:137], v[136:137], v[152:153]
    v_pk_add_f32 v[138:139], v[138:139], v[154:155]
    v_pk_add_f32 v[140:141], v[140:141], v[156:157]
    v_pk_add_f32 v[142:143], v[142:143], v[158:159]
    v_pk_add_f32 v[160:161], v[160:161], v[176:177]
    v_pk_add_f32 v[162:163], v[162:163], v[178:179]
    v_pk_add_f32 v[164:165], v[164:165], v[180:181]
    v_pk_add_f32 v[166:167], v[166:167], v[182:183]
    v_pk_add_f32 v[168:169], v[168:169], v[184:185]
    v_pk_add_f32 v[170:171], v[170:171], v[186:187]
    v_pk_add_f32 v[172:173], v[172:173], v[188:189]
    v_pk_add_f32 v[174:175], v[174:175], v[190:191]
    v_pk_add_f32 v[192:193], v[192:193], v[208:209]
    v_pk_add_f32 v[194:195], v[194:195], v[210:211]
    v_pk_add_f32 v[196:197], v[196:197], v[212:213]
    v_pk_add_f32 v[198:199], v[198:199], v[214:215]
    v_pk_add_f32 v[200:201], v[200:201], v[216:217]
    v_pk_add_f32 v[202:203], v[202:203], v[218:219]
    v_pk_add_f32 v[204:205], v[204:205], v[220:221]
    v_pk_add_f32 v[206:207], v[206:207], v[222:223]
    v_pk_add_f32 v[96:97], v[96:97], v[128:129]
    v_pk_add_f32 v[98:99], v[98:99], v[130:131]
    v_pk_add_f32 v[100:101], v[100:101], v[132:133]
    v_pk_add_f32 v[102:103], v[102:103], v[134:135]
    v_pk_add_f32 v[104:105], v[104:105], v[136:137]
    v_pk_add_f32 v[106:107], v[106:107], v[138:139]
    v_pk_add_f32 v[108:109], v[108:109], v[140:141]
    v_pk_add_f32 v[110:111], v[110:111], v[142:143]
    v_pk_add_f32 v[160:161], v[160:161], v[192:193]
    v_pk_add_f32 v[162:163], v[162:163], v[194:195]
    v_pk_add_f32 v[164:165], v[164:165], v[196:197]
    v_pk_add_f32 v[166:167], v[166:167], v[198:199]
    v_pk_add_f32 v[168:169], v[168:169], v[200:201]
    v_pk_add_f32 v[170:171], v[170:171], v[202:203]
    v_pk_add_f32 v[172:173], v[172:173], v[204:205]
    v_pk_add_f32 v[174:175], v[174:175], v[206:207]
    v_pk_add_f32 v[96:97], v[96:97], v[160:161]
    v_pk_add_f32 v[98:99], v[98:99], v[162:163]
    v_pk_add_f32 v[100:101], v[100:101], v[164:165]
    v_pk_add_f32 v[102:103], v[102:103], v[166:167]
    v_pk_add_f32 v[104:105], v[104:105], v[168:169]
    v_pk_add_f32 v[106:107], v[106:107], v[170:171]
    v_pk_add_f32 v[108:109], v[108:109], v[172:173]
    v_pk_add_f32 v[110:111], v[110:111], v[174:175]
    v_cvt_pk_bf16_f32 v48, v96, v97
    v_cvt_pk_bf16_f32 v49, v98, v99
    v_cvt_pk_bf16_f32 v50, v100, v101
    v_cvt_pk_bf16_f32 v51, v102, v103
    v_cvt_pk_bf16_f32 v52, v104, v105
    v_cvt_pk_bf16_f32 v53, v106, v107
    v_cvt_pk_bf16_f32 v54, v108, v109
    v_cvt_pk_bf16_f32 v55, v110, v111
    buffer_store_dwordx4 v[48:51], v3, s[28:31], s97 offen
    buffer_store_dwordx4 v[52:55], v3, s[28:31], s97 offen offset:128
L_fin:
L_exit:
    s_endpgm
L_ann:
    s_mov_b32 s20, 1
    v_mov_b32 v47, 1
    s_mov_b64 exec, 1
    buffer_atomic_add v47, off, s[24:27], s35 sc1
    s_mov_b64 exec, -1
    s_branch L_annr

L_clr:
    buffer_load_dword v11, off, s[24:27], s21 sc1
    s_branch L_clrr
    s_branch L_clrr
L_alt1_0:
    s_cmp_eq_u32 s10, 1
    s_cbranch_scc1 L_ret1_0
    ds_write_b128 v62, v[64:67] offset:40960
    ds_write_b128 v62, v[68:71] offset:41984
    ds_write_b128 v62, v[72:75] offset:43008
    ds_write_b128 v62, v[76:79] offset:44032
    s_branch L_ret1_0
L_alt1_1:
    s_cmp_eq_u32 s10, 1
    s_cbranch_scc1 L_ret1_1
    ds_write_b128 v63, v[80:83] offset:24576
    ds_write_b128 v63, v[84:87] offset:25600
    ds_write_b128 v63, v[88:91] offset:26624
    ds_write_b128 v63, v[92:95] offset:27648
    s_branch L_ret1_1
L_alt1_2:
    s_cmp_eq_u32 s10, 1
    s_cbranch_scc1 L_ret1_2
    ds_write_b128 v62, v[96:99] offset:0
    ds_write_b128 v62, v[100:103] offset:1024
    ds_write_b128 v62, v[104:107] offset:2048
    ds_write_b128 v62, v[108:111] offset:3072
    s_branch L_ret1_2
L_alt2_0:
    s_cmp_eq_u32 s10, 1
    s_cbranch_scc1 L_ret2_0
    ds_write_b128 v62, v[112:115] offset:8192
    ds_write_b128 v62, v[116:119] offset:9216
    ds_write_b128 v62, v[120:123] offset:10240
    ds_write_b128 v62, v[124:127] offset:11264
    s_branch L_ret2_0
L_altk4:
    s_add_u32 m0, s69, 16384
    s_xor_b32 s75, s68, 65536
    buffer_load_dwordx4 v24, s[44:47], s75 offen offset:0 nt lds
    buffer_load_dwordx4 v25, s[44:47], s75 offen offset:1024 nt lds
    s_branch L_retk4
L_altk5:
    s_add_u32 m0, s69, 24576
    s_xor_b32 s75, s68, 73728
    buffer_load_dwordx4 v24, s[44:47], s75 offen offset:0 nt lds
    buffer_load_dwordx4 v25, s[44:47], s75 offen offset:1024 nt lds
    s_branch L_retk5
L_altk6:
    s_add_u32 m0, s69, 32768
    s_xor_b32 s75, s68, 81920
    buffer_load_dwordx4 v24, s[44:47], s75 offen offset:0 nt lds
    buffer_load_dwordx4 v25, s[44:47], s75 offen offset:1024 nt lds
    s_branch L_retk6
L_altk7:
    s_add_u32 m0, s69, 40960
    s_xor_b32 s75, s68, 90112
    buffer_load_dwordx4 v24, s[44:47], s75 offen offset:0 nt lds
    buffer_load_dwordx4 v25, s[44:47], s75 offen offset:1024 nt lds
    s_branch L_retk7
L_altk8:
    s_add_u32 m0, s69, 0
    s_xor_b32 s75, s68, 98304
    buffer_load_dwordx4 v24, s[44:47], s75 offen offset:0 nt lds
    buffer_load_dwordx4 v25, s[44:47], s75 offen offset:1024 nt lds
    s_branch L_retk8
L_altk9:
    s_add_u32 m0, s69, 8192
    s_xor_b32 s75, s68, 106496
    buffer_load_dwordx4 v24, s[44:47], s75 offen offset:0 nt lds
    buffer_load_dwordx4 v25, s[44:47], s75 offen offset:1024 nt lds
    s_branch L_retk9
L_slow0:
    s_nop 7
    s_nop 7
    v_max3_f32 v40, v128, v129, v130
    v_max3_f32 v41, v131, v132, v133
    v_max3_f32 v40, v40, v134, v135
    v_max3_f32 v41, v41, v136, v137
    v_max3_f32 v40, v40, v138, v139
    v_max3_f32 v41, v41, v140, v141
    v_max3_f32 v40, v40, v142, v143
    v_max_f32 v40, v40, v41
    v_mov_b32 v41, v40
    s_nop 1
    v_permlane32_swap_b32 v40, v41
    v_max3_f32 v40, v40, v41, 0
    v_exp_f32 v41, -v40
    v_sub_f32 v128, v128, v40
    v_sub_f32 v129, v129, v40
    v_sub_f32 v130, v130, v40
    v_sub_f32 v131, v131, v40
    v_sub_f32 v132, v132, v40
    v_sub_f32 v133, v133, v40
    v_sub_f32 v134, v134, v40
    v_sub_f32 v135, v135, v40
    v_sub_f32 v136, v136, v40
    v_sub_f32 v137, v137, v40
    v_sub_f32 v138, v138, v40
    v_sub_f32 v139, v139, v40
    v_sub_f32 v140, v140, v40
    v_sub_f32 v141, v141, v40
    v_sub_f32 v142, v142, v40
    v_sub_f32 v143, v143, v40
    v_sub_f32 v144, v144, v40
    v_sub_f32 v145, v145, v40
    v_sub_f32 v146, v146, v40
    v_sub_f32 v147, v147, v40
    v_sub_f32 v148, v148, v40
    v_sub_f32 v149, v149, v40
    v_sub_f32 v150, v150, v40
    v_sub_f32 v151, v151, v40
    v_sub_f32 v152, v152, v40
    v_sub_f32 v153, v153, v40
    v_sub_f32 v154, v154, v40
    v_sub_f32 v155, v155, v40
    v_sub_f32 v156, v156, v40
    v_sub_f32 v157, v157, v40
    v_sub_f32 v158, v158, v40
    v_sub_f32 v159, v159, v40
    v_sub_f32 v192, v192, v40
    v_sub_f32 v193, v193, v40
    v_sub_f32 v194, v194, v40
    v_sub_f32 v195, v195, v40
    v_sub_f32 v196, v196, v40
    v_sub_f32 v197, v197, v40
    v_sub_f32 v198, v198, v40
    v_sub_f32 v199, v199, v40
    v_sub_f32 v200, v200, v40
    v_sub_f32 v201, v201, v40
    v_sub_f32 v202, v202, v40
    v_sub_f32 v203, v203, v40
    v_sub_f32 v204, v204, v40
    v_sub_f32 v205, v205, v40
    v_sub_f32 v206, v206, v40
    v_sub_f32 v207, v207, v40
    v_mul_f32 v64, v41, v64
    v_mul_f32 v65, v41, v65
    v_mul_f32 v66, v41, v66
    v_mul_f32 v67, v41, v67
    v_mul_f32 v68, v41, v68
    v_mul_f32 v69, v41, v69
    v_mul_f32 v70, v41, v70
    v_mul_f32 v71, v41, v71
    v_mul_f32 v72, v41, v72
    v_mul_f32 v73, v41, v73
    v_mul_f32 v74, v41, v74
    v_mul_f32 v75, v41, v75
    v_mul_f32 v76, v41, v76
    v_mul_f32 v77, v41, v77
    v_mul_f32 v78, v41, v78
    v_mul_f32 v79, v41, v79
    v_mul_f32 v80, v41, v80
    v_mul_f32 v81, v41, v81
    v_mul_f32 v82, v41, v82
    v_mul_f32 v83, v41, v83
    v_mul_f32 v84, v41, v84
    v_mul_f32 v85, v41, v85
    v_mul_f32 v86, v41, v86
    v_mul_f32 v87, v41, v87
    v_mul_f32 v88, v41, v88
    v_mul_f32 v89, v41, v89
    v_mul_f32 v90, v41, v90
    v_mul_f32 v91, v41, v91
    v_mul_f32 v92, v41, v92
    v_mul_f32 v93, v41, v93
    v_mul_f32 v94, v41, v94
    v_mul_f32 v95, v41, v95
    v_mul_f32 v96, v41, v96
    v_mul_f32 v97, v41, v97
    v_mul_f32 v98, v41, v98
    v_mul_f32 v99, v41, v99
    v_mul_f32 v100, v41, v100
    v_mul_f32 v101, v41, v101
    v_mul_f32 v102, v41, v102
    v_mul_f32 v103, v41, v103
    v_mul_f32 v104, v41, v104
    v_mul_f32 v105, v41, v105
    v_mul_f32 v106, v41, v106
    v_mul_f32 v107, v41, v107
    v_mul_f32 v108, v41, v108
    v_mul_f32 v109, v41, v109
    v_mul_f32 v110, v41, v110
    v_mul_f32 v111, v41, v111
    v_mul_f32 v112, v41, v112
    v_mul_f32 v113, v41, v113
    v_mul_f32 v114, v41, v114
    v_mul_f32 v115, v41, v115
    v_mul_f32 v116, v41, v116
    v_mul_f32 v117, v41, v117
    v_mul_f32 v118, v41, v118
    v_mul_f32 v119, v41, v119
    v_mul_f32 v120, v41, v120
    v_mul_f32 v121, v41, v121
    v_mul_f32 v122, v41, v122
    v_mul_f32 v123, v41, v123
    v_mul_f32 v124, v41, v124
    v_mul_f32 v125, v41, v125
    v_mul_f32 v126, v41, v126
    v_mul_f32 v127, v41, v127
    v_mul_f32 v29, v41, v29
    v_exp_f32 v32, v128
    v_exp_f32 v33, v129
    v_exp_f32 v34, v130
    v_exp_f32 v35, v131
    v_cvt_pk_bf16_f32 v208, v32, v33
    v_exp_f32 v36, v132
    v_exp_f32 v37, v133
    v_add_f32 v30, v32, v34
    v_add_f32 v31, v33, v35
    v_cvt_pk_bf16_f32 v209, v34, v35
    v_exp_f32 v38, v134
    v_exp_f32 v39, v135
    v_add_f32 v30, v30, v36
    v_add_f32 v31, v31, v37
    v_cvt_pk_bf16_f32 v210, v36, v37
    v_exp_f32 v32, v136
    v_exp_f32 v33, v137
    v_add_f32 v30, v30, v38
    v_add_f32 v31, v31, v39
    v_cvt_pk_bf16_f32 v211, v38, v39
    v_exp_f32 v34, v138
    v_exp_f32 v35, v139
    v_add_f32 v30, v30, v32
    v_add_f32 v31, v31, v33
    v_cvt_pk_bf16_f32 v212, v32, v33
    v_exp_f32 v36, v140
    v_exp_f32 v37, v141
    v_add_f32 v30, v30, v34
    v_add_f32 v31, v31, v35
    v_cvt_pk_bf16_f32 v213, v34, v35
    v_exp_f32 v38, v142
    v_exp_f32 v39, v143
    v_add_f32 v30, v30, v36
    v_add_f32 v31, v31, v37
    v_cvt_pk_bf16_f32 v214, v36, v37
    v_add_f32 v30, v30, v38
    v_add_f32 v31, v31, v39
    v_cvt_pk_bf16_f32 v215, v38, v39
    v_add_f32 v30, v30, v31
    s_cmp_eq_u32 s72, 2
    s_cbranch_scc1 L_back2
    s_cmp_eq_u32 s72, 4
    s_cbranch_scc1 L_back4
    s_cmp_eq_u32 s72, 6
    s_cbranch_scc1 L_back6
    s_cmp_eq_u32 s72, 8
    s_cbranch_scc1 L_back8
    s_cmp_eq_u32 s72, 10
    s_cbranch_scc1 L_back10
    s_cmp_eq_u32 s72, 12
    s_cbranch_scc1 L_back12
    s_branch L_back14
L_slow1:
    s_nop 7
    s_nop 7
    v_max3_f32 v40, v144, v145, v146
    v_max3_f32 v41, v147, v148, v149
    v_max3_f32 v40, v40, v150, v151
    v_max3_f32 v41, v41, v152, v153
    v_max3_f32 v40, v40, v154, v155
    v_max3_f32 v41, v41, v156, v157
    v_max3_f32 v40, v40, v158, v159
    v_max_f32 v40, v40, v41
    v_mov_b32 v41, v40
    s_nop 1
    v_permlane32_swap_b32 v40, v41
    v_max3_f32 v40, v40, v41, 0
    v_exp_f32 v41, -v40
    v_sub_f32 v128, v128, v40
    v_sub_f32 v129, v129, v40
    v_sub_f32 v130, v130, v40
    v_sub_f32 v131, v131, v40
    v_sub_f32 v132, v132, v40
    v_sub_f32 v133, v133, v40
    v_sub_f32 v134, v134, v40
    v_sub_f32 v135, v135, v40
    v_sub_f32 v136, v136, v40
    v_sub_f32 v137, v137, v40
    v_sub_f32 v138, v138, v40
    v_sub_f32 v139, v139, v40
    v_sub_f32 v140, v140, v40
    v_sub_f32 v141, v141, v40
    v_sub_f32 v142, v142, v40
    v_sub_f32 v143, v143, v40
    v_sub_f32 v144, v144, v40
    v_sub_f32 v145, v145, v40
    v_sub_f32 v146, v146, v40
    v_sub_f32 v147, v147, v40
    v_sub_f32 v148, v148, v40
    v_sub_f32 v149, v149, v40
    v_sub_f32 v150, v150, v40
    v_sub_f32 v151, v151, v40
    v_sub_f32 v152, v152, v40
    v_sub_f32 v153, v153, v40
    v_sub_f32 v154, v154, v40
    v_sub_f32 v155, v155, v40
    v_sub_f32 v156, v156, v40
    v_sub_f32 v157, v157, v40
    v_sub_f32 v158, v158, v40
    v_sub_f32 v159, v159, v40
    v_sub_f32 v192, v192, v40
    v_sub_f32 v193, v193, v40
    v_sub_f32 v194, v194, v40
    v_sub_f32 v195, v195, v40
    v_sub_f32 v196, v196, v40
    v_sub_f32 v197, v197, v40
    v_sub_f32 v198, v198, v40
    v_sub_f32 v199, v199, v40
    v_sub_f32 v200, v200, v40
    v_sub_f32 v201, v201, v40
    v_sub_f32 v202, v202, v40
    v_sub_f32 v203, v203, v40
    v_sub_f32 v204, v204, v40
    v_sub_f32 v205, v205, v40
    v_sub_f32 v206, v206, v40
    v_sub_f32 v207, v207, v40
    v_mul_f32 v64, v41, v64
    v_mul_f32 v65, v41, v65
    v_mul_f32 v66, v41, v66
    v_mul_f32 v67, v41, v67
    v_mul_f32 v68, v41, v68
    v_mul_f32 v69, v41, v69
    v_mul_f32 v70, v41, v70
    v_mul_f32 v71, v41, v71
    v_mul_f32 v72, v41, v72
    v_mul_f32 v73, v41, v73
    v_mul_f32 v74, v41, v74
    v_mul_f32 v75, v41, v75
    v_mul_f32 v76, v41, v76
    v_mul_f32 v77, v41, v77
    v_mul_f32 v78, v41, v78
    v_mul_f32 v79, v41, v79
    v_mul_f32 v80, v41, v80
    v_mul_f32 v81, v41, v81
    v_mul_f32 v82, v41, v82
    v_mul_f32 v83, v41, v83
    v_mul_f32 v84, v41, v84
    v_mul_f32 v85, v41, v85
    v_mul_f32 v86, v41, v86
    v_mul_f32 v87, v41, v87
    v_mul_f32 v88, v41, v88
    v_mul_f32 v89, v41, v89
    v_mul_f32 v90, v41, v90
    v_mul_f32 v91, v41, v91
    v_mul_f32 v92, v41, v92
    v_mul_f32 v93, v41, v93
    v_mul_f32 v94, v41, v94
    v_mul_f32 v95, v41, v95
    v_mul_f32 v96, v41, v96
    v_mul_f32 v97, v41, v97
    v_mul_f32 v98, v41, v98
    v_mul_f32 v99, v41, v99
    v_mul_f32 v100, v41, v100
    v_mul_f32 v101, v41, v101
    v_mul_f32 v102, v41, v102
    v_mul_f32 v103, v41, v103
    v_mul_f32 v104, v41, v104
    v_mul_f32 v105, v41, v105
    v_mul_f32 v106, v41, v106
    v_mul_f32 v107, v41, v107
    v_mul_f32 v108, v41, v108
    v_mul_f32 v109, v41, v109
    v_mul_f32 v110, v41, v110
    v_mul_f32 v111, v41, v111
    v_mul_f32 v112, v41, v112
    v_mul_f32 v113, v41, v113
    v_mul_f32 v114, v41, v114
    v_mul_f32 v115, v41, v115
    v_mul_f32 v116, v41, v116
    v_mul_f32 v117, v41, v117
    v_mul_f32 v118, v41, v118
    v_mul_f32 v119, v41, v119
    v_mul_f32 v120, v41, v120
    v_mul_f32 v121, v41, v121
    v_mul_f32 v122, v41, v122
    v_mul_f32 v123, v41, v123
    v_mul_f32 v124, v41, v124
    v_mul_f32 v125, v41, v125
    v_mul_f32 v126, v41, v126
    v_mul_f32 v127, v41, v127
    v_mul_f32 v29, v41, v29
    v_exp_f32 v32, v144
    v_exp_f32 v33, v145
    v_exp_f32 v34, v146
    v_exp_f32 v35, v147
    v_cvt_pk_bf16_f32 v216, v32, v33
    v_exp_f32 v36, v148
    v_exp_f32 v37, v149
    v_add_f32 v30, v32, v34
    v_add_f32 v31, v33, v35
    v_cvt_pk_bf16_f32 v217, v34, v35
    v_exp_f32 v38, v150
    v_exp_f32 v39, v151
    v_add_f32 v30, v30, v36
    v_add_f32 v31, v31, v37
    v_cvt_pk_bf16_f32 v218, v36, v37
    v_exp_f32 v32, v152
    v_exp_f32 v33, v153
    v_add_f32 v30, v30, v38
    v_add_f32 v31, v31, v39
    v_cvt_pk_bf16_f32 v219, v38, v39
    v_exp_f32 v34, v154
    v_exp_f32 v35, v155
    v_add_f32 v30, v30, v32
    v_add_f32 v31, v31, v33
    v_cvt_pk_bf16_f32 v220, v32, v33
    v_exp_f32 v36, v156
    v_exp_f32 v37, v157
    v_add_f32 v30, v30, v34
    v_add_f32 v31, v31, v35
    v_cvt_pk_bf16_f32 v221, v34, v35
    v_exp_f32 v38, v158
    v_exp_f32 v39, v159
    v_add_f32 v30, v30, v36
    v_add_f32 v31, v31, v37
    v_cvt_pk_bf16_f32 v222, v36, v37
    v_add_f32 v30, v30, v38
    v_add_f32 v31, v31, v39
    v_cvt_pk_bf16_f32 v223, v38, v39
    v_add_f32 v30, v30, v31
    s_cmp_eq_u32 s72, 1
    s_cbranch_scc1 L_back1
    s_cmp_eq_u32 s72, 3
    s_cbranch_scc1 L_back3
    s_cmp_eq_u32 s72, 5
    s_cbranch_scc1 L_back5
    s_cmp_eq_u32 s72, 7
    s_cbranch_scc1 L_back7
    s_cmp_eq_u32 s72, 9
    s_cbranch_scc1 L_back9
    s_cmp_eq_u32 s72, 11
    s_cbranch_scc1 L_back11
    s_cmp_eq_u32 s72, 13
    s_cbranch_scc1 L_back13
    s_branch L_back15
.section .rodata,"a"
.p2align 6
.amdhsa_kernel concat_heads__gqa_block_cached__gqa_block_cached__near_ridge_kernel
  .amdhsa_next_free_vgpr 256
  .amdhsa_next_free_sgpr 102
  .amdhsa_accum_offset 256
  .amdhsa_group_segment_fixed_size 0
  .amdhsa_kernarg_size 104
  .amdhsa_user_sgpr_count 2
  .amdhsa_user_sgpr_kernarg_segment_ptr 1
  .amdhsa_system_sgpr_workgroup_id_x 1
.end_amdhsa_kernel
```
